```python
import torch

def _softmax(x, axis=-1):
    return torch.softmax(x, dim=axis)
def _gelu(x):
    return torch.nn.functional.gelu(x, approximate="tanh")
def _silu(x):
    return torch.nn.functional.silu(x)
def _sigmoid(x):
    return torch.sigmoid(x)
def _layernorm(x, axis=-1, eps=1e-5):
    m = x.mean(dim=axis, keepdim=True)
    v = x.var(dim=axis, keepdim=True, unbiased=False)
    return (x - m) / torch.sqrt(v + eps)
def _scatter_add(tgt, idx, src, axis=0):
    return tgt.clone().index_add_(axis, idx, src)
def _segment_sum(src, seg, n):
    out = torch.zeros((n,) + src.shape[1:], dtype=src.dtype)
    return out.index_add_(0, seg, src)
def _pad(x, pw):
    flat = tuple(v for pair in reversed(pw) for v in pair)
    return torch.nn.functional.pad(x, flat)

kernel_name = 'standalone__gqa_softmax__near_ridge'

def setup_inputs():

    _w = (lambda a: (lambda t: t.to(torch.bfloat16) if t.is_floating_point() else t)(torch.as_tensor(a)))
    B, Hq, Hkv, Sq, Sk, D = 8, 32, 16, 96, 2048, 128
    return {
        "q": _w((lambda *s: torch.randn(*s, dtype=torch.bfloat16) * 0.8)(B, Hq, Sq, D)),
        "k": _w((lambda *s: torch.randn(*s, dtype=torch.bfloat16) * 0.8)(B, Hkv, Sk, D)),
        "v": _w((lambda *s: torch.randn(*s, dtype=torch.bfloat16) * 0.05)(B, Hkv, Sk, D)),
    }

def reference(q, k, v):
    B, Hq, Sq, D = q.shape
    Hkv = k.shape[1]
    rep = Hq // Hkv
    k = (lambda x, n, axis: torch.repeat_interleave(x, n, dim=axis))(k, rep, axis=1)
    v = (lambda x, n, axis: torch.repeat_interleave(x, n, dim=axis))(v, rep, axis=1)
    scale = D ** -0.5
    scores = torch.einsum("bhqd,bhkd->bhqk", q, k) * scale
    p = _softmax(scores, axis=-1)
    return torch.einsum("bhqk,bhkd->bhqd", p, v)
```

```asm
; @launch grid=(256,1,1) block=(256,1,1) lds=163840
.amdgcn_target "amdgcn-amd-amdhsa--gfx950"
.text
.globl standalone__gqa_softmax__near_ridge_kernel
.p2align 8
.type standalone__gqa_softmax__near_ridge_kernel,@function
standalone__gqa_softmax__near_ridge_kernel:
    s_cmp_ge_u32 s2, 256
    s_cbranch_scc1 L_END
    s_load_dwordx4 s[4:7], s[0:1], 0
    s_load_dwordx4 s[8:11], s[0:1], 16
    v_lshrrev_b32 v1, 6, v0
    v_and_b32 v240, 63, v0
    v_readfirstlane_b32 s28, v1
    s_and_b32 s40, s2, 7
    s_lshr_b32 s41, s2, 3
    s_lshr_b32 s42, s41, 1
    s_lshl_b32 s42, s42, 3
    s_add_u32 s42, s42, s40
    s_and_b32 s41, s41, 1
    s_lshl_b32 s43, s42, 1
    s_add_u32 s43, s43, s41
    s_mul_i32 s39, s28, 40960
    s_lshr_b32 s30, s28, 1
    s_xor_b32 s30, s30, s41
    s_xor_b32 s30, s30, 1
    s_mul_i32 s30, s30, 0
    s_mov_b32 s29, 0x3e0293ee
    v_lshrrev_b32 v2, 5, v240
    v_and_b32 v3, 31, v240
    v_lshrrev_b32 v4, 4, v240
    v_and_b32 v5, 15, v240
    v_lshlrev_b32 v6, 2, v4
    v_xor_b32 v5, v5, v6
    v_lshlrev_b32 v5, 4, v5
    v_lshl_add_u32 v236, v4, 8, v5
    v_xor_b32 v237, 16, v236
    v_xor_b32 v238, 32, v236
    v_xor_b32 v239, 48, v236
    s_waitcnt lgkmcnt(0)
    s_mul_i32 s44, s43, 24576
    s_add_u32 s12, s4, s44
    s_addc_u32 s13, s5, 0
    s_mov_b32 s14, 24576
    s_mov_b32 s15, 0x00020000
    s_add_u32 s24, s10, s44
    s_addc_u32 s25, s11, 0
    s_mov_b32 s26, 24576
    s_mov_b32 s27, 0x00020000
    s_lshl_b32 s44, s42, 19
    s_lshl_b32 s45, s28, 13
    s_add_u32 s44, s44, s45
    s_sub_u32 s47, 524288, s45
    s_add_u32 s16, s6, s44
    s_addc_u32 s17, s7, 0
    s_mov_b32 s18, s47
    s_mov_b32 s19, 0x00020000
    s_add_u32 s20, s8, s44
    s_addc_u32 s21, s9, 0
    s_mov_b32 s22, s47
    s_mov_b32 s23, 0x00020000
    s_mul_i32 s48, s28, 6144
    v_lshlrev_b32 v9, 4, v240
    buffer_load_dwordx4 v[16:19], v9, s[12:15], s48 offen offset:0
    v_add_u32 v13, 4096, v9
    buffer_load_dwordx4 v[20:23], v9, s[12:15], s48 offen offset:1024
    buffer_load_dwordx4 v[24:27], v9, s[12:15], s48 offen offset:2048
    buffer_load_dwordx4 v[28:31], v9, s[12:15], s48 offen offset:3072
    buffer_load_dwordx4 v[32:35], v13, s[12:15], s48 offen offset:0
    buffer_load_dwordx4 v[36:39], v13, s[12:15], s48 offen offset:1024
    s_add_u32 s46, s30, 0
    s_and_b32 s46, s46, 15
    s_lshl_b32 s36, s46, 15
    s_add_u32 s37, s36, 4096
    s_mov_b32 s34, s36
    s_mov_b32 s35, s37
    s_add_u32 m0, s39, 0
    s_nop 0
    buffer_load_dwordx4 v236, s[16:19], s36 offen offset:0 nt lds
    buffer_load_dwordx4 v237, s[16:19], s36 offen offset:1024 nt lds
    buffer_load_dwordx4 v238, s[16:19], s36 offen offset:2048 nt lds
    buffer_load_dwordx4 v239, s[16:19], s36 offen offset:3072 nt lds
    s_add_u32 m0, s39, 4096
    s_nop 0
    buffer_load_dwordx4 v236, s[16:19], s37 offen offset:0 nt lds
    buffer_load_dwordx4 v237, s[16:19], s37 offen offset:1024 nt lds
    buffer_load_dwordx4 v238, s[16:19], s37 offen offset:2048 nt lds
    buffer_load_dwordx4 v239, s[16:19], s37 offen offset:3072 nt lds
    v_and_b32 v4, 3, v3
    v_lshlrev_b32 v4, 2, v4
    v_bfe_u32 v5, v3, 2, 2
    v_or_b32 v4, v4, v5
    v_xor_b32 v4, v4, v2
    v_lshlrev_b32 v4, 4, v4
    v_lshl_add_u32 v4, v3, 8, v4
    v_add_u32 v4, s39, v4
    v_xor_b32 v220, 0, v4
    v_xor_b32 v221, 32, v4
    v_xor_b32 v222, 64, v4
    v_xor_b32 v223, 96, v4
    v_xor_b32 v224, 128, v4
    v_xor_b32 v225, 160, v4
    v_xor_b32 v226, 192, v4
    v_xor_b32 v227, 224, v4
    v_bfe_u32 v4, v240, 4, 1
    v_bfe_u32 v5, v240, 2, 2
    v_and_b32 v6, 3, v240
    v_lshrrev_b32 v7, 1, v6
    v_lshl_add_u32 v7, v4, 1, v7
    v_xor_b32 v7, v7, v2
    v_lshl_or_b32 v7, v5, 2, v7
    v_lshlrev_b32 v7, 4, v7
    v_and_b32 v6, 1, v6
    v_lshl_add_u32 v7, v6, 3, v7
    v_lshl_add_u32 v8, v2, 2, v5
    v_lshl_add_u32 v7, v8, 8, v7
    v_add_u32 v7, s39, v7
    v_xor_b32 v228, 0, v7
    v_xor_b32 v229, 32, v7
    v_xor_b32 v230, 64, v7
    v_xor_b32 v231, 96, v7
    v_xor_b32 v232, 128, v7
    v_xor_b32 v233, 160, v7
    v_xor_b32 v234, 192, v7
    v_xor_b32 v235, 224, v7
    s_lshl_b32 s44, s28, 6
    v_lshlrev_b32 v4, 4, v2
    v_lshl_add_u32 v4, v3, 8, v4
    v_add_u32 v241, s44, v4
    v_add_u32 v4, 0, v3
    v_mul_u32_u24 v5, 2731, v4
    v_lshrrev_b32 v5, 16, v5
    v_mul_u32_u24 v6, 24, v5
    v_sub_u32 v6, v4, v6
    v_and_b32 v7, 3, v6
    v_lshlrev_b32 v7, 2, v7
    v_bfe_u32 v8, v6, 2, 2
    v_or_b32 v7, v7, v8
    v_xor_b32 v7, v7, v2
    v_lshlrev_b32 v7, 4, v7
    v_lshl_add_u32 v7, v6, 8, v7
    v_mul_u32_u24 v5, 40960, v5
    v_add_u32 v7, v7, v5
    v_add_u32 v10, 32768, v7
    v_add_u32 v4, 32, v3
    v_mul_u32_u24 v5, 2731, v4
    v_lshrrev_b32 v5, 16, v5
    v_mul_u32_u24 v6, 24, v5
    v_sub_u32 v6, v4, v6
    v_and_b32 v7, 3, v6
    v_lshlrev_b32 v7, 2, v7
    v_bfe_u32 v8, v6, 2, 2
    v_or_b32 v7, v7, v8
    v_xor_b32 v7, v7, v2
    v_lshlrev_b32 v7, 4, v7
    v_lshl_add_u32 v7, v6, 8, v7
    v_mul_u32_u24 v5, 40960, v5
    v_add_u32 v7, v7, v5
    v_add_u32 v11, 32768, v7
    v_add_u32 v4, 64, v3
    v_mul_u32_u24 v5, 2731, v4
    v_lshrrev_b32 v5, 16, v5
    v_mul_u32_u24 v6, 24, v5
    v_sub_u32 v6, v4, v6
    v_and_b32 v7, 3, v6
    v_lshlrev_b32 v7, 2, v7
    v_bfe_u32 v8, v6, 2, 2
    v_or_b32 v7, v7, v8
    v_xor_b32 v7, v7, v2
    v_lshlrev_b32 v7, 4, v7
    v_lshl_add_u32 v7, v6, 8, v7
    v_mul_u32_u24 v5, 40960, v5
    v_add_u32 v7, v7, v5
    v_add_u32 v12, 32768, v7
    v_mov_b32 v200, 0xff800000
    v_mov_b32 v206, 0xff800000
    v_mov_b32 v209, 0
    v_mov_b32 v203, 0
    v_mov_b32 v201, 0xff800000
    v_mov_b32 v207, 0xff800000
    v_mov_b32 v210, 0
    v_mov_b32 v204, 0
    v_mov_b32 v202, 0xff800000
    v_mov_b32 v208, 0xff800000
    v_mov_b32 v211, 0
    v_mov_b32 v205, 0
    v_mov_b32 v184, 0
    v_mov_b32 v185, 0
    v_mov_b32 v186, 0
    v_mov_b32 v187, 0
    v_mov_b32 v188, 0
    v_mov_b32 v189, 0
    v_mov_b32 v190, 0
    v_mov_b32 v191, 0
    v_mov_b32 v192, 0
    v_mov_b32 v193, 0
    v_mov_b32 v194, 0
    v_mov_b32 v195, 0
    v_mov_b32 v196, 0
    v_mov_b32 v197, 0
    v_mov_b32 v198, 0
    v_mov_b32 v199, 0
    v_mov_b32 v4, 0x3f80
    v_cmp_eq_u32 vcc, 0, v2
    s_nop 1
    v_cndmask_b32 v196, 0, v4, vcc
    s_add_u32 s47, s39, 32768
    v_add_u32 v212, s47, v236
    v_add_u32 v213, s47, v237
    v_add_u32 v214, s47, v238
    v_add_u32 v215, s47, v239
    s_add_u32 m0, s39, 16384
    s_nop 0
    buffer_load_dwordx4 v236, s[20:23], s34 offen offset:0 nt lds
    v_mov_b32 v120, 0
    v_mov_b32 v121, 0
    v_mov_b32 v122, 0
    v_mov_b32 v123, 0
    v_mov_b32 v124, 0
    v_mov_b32 v125, 0
    v_mov_b32 v126, 0
    v_mov_b32 v127, 0
    v_mov_b32 v128, 0
    v_mov_b32 v129, 0
    v_mov_b32 v130, 0
    v_mov_b32 v131, 0
    v_mov_b32 v132, 0
    v_mov_b32 v133, 0
    v_mov_b32 v134, 0
    v_mov_b32 v135, 0
    v_mov_b32 v136, 0
    v_mov_b32 v137, 0
    v_mov_b32 v138, 0
    v_mov_b32 v139, 0
    v_mov_b32 v140, 0
    v_mov_b32 v141, 0
    v_mov_b32 v142, 0
    v_mov_b32 v143, 0
    v_mov_b32 v144, 0
    v_mov_b32 v145, 0
    v_mov_b32 v146, 0
    v_mov_b32 v147, 0
    v_mov_b32 v148, 0
    v_mov_b32 v149, 0
    v_mov_b32 v150, 0
    buffer_load_dwordx4 v237, s[20:23], s34 offen offset:1024 nt lds
    v_mov_b32 v151, 0
    v_mov_b32 v64, 0
    v_mov_b32 v65, 0
    v_mov_b32 v66, 0
    v_mov_b32 v67, 0
    v_mov_b32 v68, 0
    v_mov_b32 v69, 0
    v_mov_b32 v70, 0
    v_mov_b32 v71, 0
    v_mov_b32 v72, 0
    v_mov_b32 v73, 0
    v_mov_b32 v74, 0
    v_mov_b32 v75, 0
    v_mov_b32 v76, 0
    v_mov_b32 v77, 0
    v_mov_b32 v78, 0
    v_mov_b32 v79, 0
    v_mov_b32 v80, 0
    v_mov_b32 v81, 0
    v_mov_b32 v82, 0
    v_mov_b32 v83, 0
    v_mov_b32 v84, 0
    v_mov_b32 v85, 0
    v_mov_b32 v86, 0
    v_mov_b32 v87, 0
    v_accvgpr_write_b32 a0, 0
    v_accvgpr_write_b32 a1, 0
    v_accvgpr_write_b32 a2, 0
    v_accvgpr_write_b32 a3, 0
    v_accvgpr_write_b32 a4, 0
    v_accvgpr_write_b32 a5, 0
    buffer_load_dwordx4 v238, s[20:23], s34 offen offset:2048 nt lds
    v_accvgpr_write_b32 a6, 0
    v_accvgpr_write_b32 a7, 0
    v_accvgpr_write_b32 a8, 0
    v_accvgpr_write_b32 a9, 0
    v_accvgpr_write_b32 a10, 0
    v_accvgpr_write_b32 a11, 0
    v_accvgpr_write_b32 a12, 0
    v_accvgpr_write_b32 a13, 0
    v_accvgpr_write_b32 a14, 0
    v_accvgpr_write_b32 a15, 0
    v_accvgpr_write_b32 a16, 0
    v_accvgpr_write_b32 a17, 0
    v_accvgpr_write_b32 a18, 0
    v_accvgpr_write_b32 a19, 0
    v_accvgpr_write_b32 a20, 0
    v_accvgpr_write_b32 a21, 0
    v_accvgpr_write_b32 a22, 0
    v_accvgpr_write_b32 a23, 0
    v_accvgpr_write_b32 a24, 0
    v_accvgpr_write_b32 a25, 0
    v_accvgpr_write_b32 a26, 0
    v_accvgpr_write_b32 a27, 0
    v_accvgpr_write_b32 a28, 0
    v_accvgpr_write_b32 a29, 0
    v_accvgpr_write_b32 a30, 0
    v_accvgpr_write_b32 a31, 0
    v_accvgpr_write_b32 a32, 0
    v_accvgpr_write_b32 a33, 0
    v_accvgpr_write_b32 a34, 0
    v_accvgpr_write_b32 a35, 0
    v_accvgpr_write_b32 a36, 0
    buffer_load_dwordx4 v239, s[20:23], s34 offen offset:3072 nt lds
    v_accvgpr_write_b32 a37, 0
    v_accvgpr_write_b32 a38, 0
    v_accvgpr_write_b32 a39, 0
    v_accvgpr_write_b32 a40, 0
    v_accvgpr_write_b32 a41, 0
    v_accvgpr_write_b32 a42, 0
    v_accvgpr_write_b32 a43, 0
    v_accvgpr_write_b32 a44, 0
    v_accvgpr_write_b32 a45, 0
    v_accvgpr_write_b32 a46, 0
    v_accvgpr_write_b32 a47, 0
    v_accvgpr_write_b32 a48, 0
    v_accvgpr_write_b32 a49, 0
    v_accvgpr_write_b32 a50, 0
    v_accvgpr_write_b32 a51, 0
    v_accvgpr_write_b32 a52, 0
    v_accvgpr_write_b32 a53, 0
    v_accvgpr_write_b32 a54, 0
    v_accvgpr_write_b32 a55, 0
    v_accvgpr_write_b32 a56, 0
    v_accvgpr_write_b32 a57, 0
    v_accvgpr_write_b32 a58, 0
    v_accvgpr_write_b32 a59, 0
    v_accvgpr_write_b32 a60, 0
    v_accvgpr_write_b32 a61, 0
    v_accvgpr_write_b32 a62, 0
    v_accvgpr_write_b32 a63, 0
    v_accvgpr_write_b32 a64, 0
    v_accvgpr_write_b32 a65, 0
    v_accvgpr_write_b32 a66, 0
    v_accvgpr_write_b32 a67, 0
    s_add_u32 m0, s39, 20480
    s_nop 0
    buffer_load_dwordx4 v236, s[20:23], s35 offen offset:0 nt lds
    v_accvgpr_write_b32 a68, 0
    v_accvgpr_write_b32 a69, 0
    v_accvgpr_write_b32 a70, 0
    v_accvgpr_write_b32 a71, 0
    v_accvgpr_write_b32 a72, 0
    v_accvgpr_write_b32 a73, 0
    v_accvgpr_write_b32 a74, 0
    v_accvgpr_write_b32 a75, 0
    v_accvgpr_write_b32 a76, 0
    v_accvgpr_write_b32 a77, 0
    v_accvgpr_write_b32 a78, 0
    v_accvgpr_write_b32 a79, 0
    v_accvgpr_write_b32 a80, 0
    v_accvgpr_write_b32 a81, 0
    v_accvgpr_write_b32 a82, 0
    v_accvgpr_write_b32 a83, 0
    v_accvgpr_write_b32 a84, 0
    v_accvgpr_write_b32 a85, 0
    v_accvgpr_write_b32 a86, 0
    v_accvgpr_write_b32 a87, 0
    v_accvgpr_write_b32 a88, 0
    v_accvgpr_write_b32 a89, 0
    v_accvgpr_write_b32 a90, 0
    v_accvgpr_write_b32 a91, 0
    v_accvgpr_write_b32 a92, 0
    v_accvgpr_write_b32 a93, 0
    v_accvgpr_write_b32 a94, 0
    v_accvgpr_write_b32 a95, 0
    v_accvgpr_write_b32 a96, 0
    v_accvgpr_write_b32 a97, 0
    v_accvgpr_write_b32 a98, 0
    buffer_load_dwordx4 v237, s[20:23], s35 offen offset:1024 nt lds
    v_accvgpr_write_b32 a99, 0
    v_accvgpr_write_b32 a100, 0
    v_accvgpr_write_b32 a101, 0
    v_accvgpr_write_b32 a102, 0
    v_accvgpr_write_b32 a103, 0
    v_accvgpr_write_b32 a104, 0
    v_accvgpr_write_b32 a105, 0
    v_accvgpr_write_b32 a106, 0
    v_accvgpr_write_b32 a107, 0
    v_accvgpr_write_b32 a108, 0
    v_accvgpr_write_b32 a109, 0
    v_accvgpr_write_b32 a110, 0
    v_accvgpr_write_b32 a111, 0
    v_accvgpr_write_b32 a112, 0
    v_accvgpr_write_b32 a113, 0
    v_accvgpr_write_b32 a114, 0
    v_accvgpr_write_b32 a115, 0
    v_accvgpr_write_b32 a116, 0
    v_accvgpr_write_b32 a117, 0
    v_accvgpr_write_b32 a118, 0
    v_accvgpr_write_b32 a119, 0
    v_accvgpr_write_b32 a120, 0
    v_accvgpr_write_b32 a121, 0
    v_accvgpr_write_b32 a122, 0
    v_accvgpr_write_b32 a123, 0
    v_accvgpr_write_b32 a124, 0
    v_accvgpr_write_b32 a125, 0
    v_accvgpr_write_b32 a126, 0
    v_accvgpr_write_b32 a127, 0
    v_accvgpr_write_b32 a128, 0
    v_accvgpr_write_b32 a129, 0
    buffer_load_dwordx4 v238, s[20:23], s35 offen offset:2048 nt lds
    v_accvgpr_write_b32 a130, 0
    v_accvgpr_write_b32 a131, 0
    v_accvgpr_write_b32 a132, 0
    v_accvgpr_write_b32 a133, 0
    v_accvgpr_write_b32 a134, 0
    v_accvgpr_write_b32 a135, 0
    v_accvgpr_write_b32 a136, 0
    v_accvgpr_write_b32 a137, 0
    v_accvgpr_write_b32 a138, 0
    v_accvgpr_write_b32 a139, 0
    v_accvgpr_write_b32 a140, 0
    v_accvgpr_write_b32 a141, 0
    v_accvgpr_write_b32 a142, 0
    v_accvgpr_write_b32 a143, 0
    v_accvgpr_write_b32 a144, 0
    v_accvgpr_write_b32 a145, 0
    v_accvgpr_write_b32 a146, 0
    v_accvgpr_write_b32 a147, 0
    v_accvgpr_write_b32 a148, 0
    v_accvgpr_write_b32 a149, 0
    v_accvgpr_write_b32 a150, 0
    v_accvgpr_write_b32 a151, 0
    v_accvgpr_write_b32 a152, 0
    v_accvgpr_write_b32 a153, 0
    v_accvgpr_write_b32 a154, 0
    v_accvgpr_write_b32 a155, 0
    v_accvgpr_write_b32 a156, 0
    v_accvgpr_write_b32 a157, 0
    v_accvgpr_write_b32 a158, 0
    v_accvgpr_write_b32 a159, 0
    v_accvgpr_write_b32 a160, 0
    buffer_load_dwordx4 v239, s[20:23], s35 offen offset:3072 nt lds
    v_accvgpr_write_b32 a161, 0
    v_accvgpr_write_b32 a162, 0
    v_accvgpr_write_b32 a163, 0
    v_accvgpr_write_b32 a164, 0
    v_accvgpr_write_b32 a165, 0
    v_accvgpr_write_b32 a166, 0
    v_accvgpr_write_b32 a167, 0
    v_accvgpr_write_b32 a168, 0
    v_accvgpr_write_b32 a169, 0
    v_accvgpr_write_b32 a170, 0
    v_accvgpr_write_b32 a171, 0
    v_accvgpr_write_b32 a172, 0
    v_accvgpr_write_b32 a173, 0
    v_accvgpr_write_b32 a174, 0
    v_accvgpr_write_b32 a175, 0
    v_accvgpr_write_b32 a176, 0
    v_accvgpr_write_b32 a177, 0
    v_accvgpr_write_b32 a178, 0
    v_accvgpr_write_b32 a179, 0
    v_accvgpr_write_b32 a180, 0
    v_accvgpr_write_b32 a181, 0
    v_accvgpr_write_b32 a182, 0
    v_accvgpr_write_b32 a183, 0
    v_accvgpr_write_b32 a184, 0
    v_accvgpr_write_b32 a185, 0
    v_accvgpr_write_b32 a186, 0
    v_accvgpr_write_b32 a187, 0
    v_accvgpr_write_b32 a188, 0
    v_accvgpr_write_b32 a189, 0
    v_accvgpr_write_b32 a190, 0
    v_accvgpr_write_b32 a191, 0
    s_waitcnt vmcnt(16)
    v_lshlrev_b32 v40, 16, v16
    v_and_b32 v41, 0xffff0000, v16
    v_mul_f32 v40, s29, v40
    v_mul_f32 v41, s29, v41
    v_cvt_pk_bf16_f32 v16, v40, v41
    v_lshlrev_b32 v42, 16, v17
    v_and_b32 v43, 0xffff0000, v17
    v_mul_f32 v42, s29, v42
    v_mul_f32 v43, s29, v43
    v_cvt_pk_bf16_f32 v17, v42, v43
    v_lshlrev_b32 v40, 16, v18
    v_and_b32 v41, 0xffff0000, v18
    v_mul_f32 v40, s29, v40
    v_mul_f32 v41, s29, v41
    v_cvt_pk_bf16_f32 v18, v40, v41
    v_lshlrev_b32 v42, 16, v19
    v_and_b32 v43, 0xffff0000, v19
    v_mul_f32 v42, s29, v42
    v_mul_f32 v43, s29, v43
    v_cvt_pk_bf16_f32 v19, v42, v43
    ds_write_b128 v212, v[16:19] offset:0
    v_lshlrev_b32 v40, 16, v20
    v_and_b32 v41, 0xffff0000, v20
    v_mul_f32 v40, s29, v40
    v_mul_f32 v41, s29, v41
    v_cvt_pk_bf16_f32 v20, v40, v41
    v_lshlrev_b32 v42, 16, v21
    v_and_b32 v43, 0xffff0000, v21
    v_mul_f32 v42, s29, v42
    v_mul_f32 v43, s29, v43
    v_cvt_pk_bf16_f32 v21, v42, v43
    v_lshlrev_b32 v40, 16, v22
    v_and_b32 v41, 0xffff0000, v22
    v_mul_f32 v40, s29, v40
    v_mul_f32 v41, s29, v41
    v_cvt_pk_bf16_f32 v22, v40, v41
    v_lshlrev_b32 v42, 16, v23
    v_and_b32 v43, 0xffff0000, v23
    v_mul_f32 v42, s29, v42
    v_mul_f32 v43, s29, v43
    v_cvt_pk_bf16_f32 v23, v42, v43
    ds_write_b128 v213, v[20:23] offset:1024
    v_lshlrev_b32 v40, 16, v24
    v_and_b32 v41, 0xffff0000, v24
    v_mul_f32 v40, s29, v40
    v_mul_f32 v41, s29, v41
    v_cvt_pk_bf16_f32 v24, v40, v41
    v_lshlrev_b32 v42, 16, v25
    v_and_b32 v43, 0xffff0000, v25
    v_mul_f32 v42, s29, v42
    v_mul_f32 v43, s29, v43
    v_cvt_pk_bf16_f32 v25, v42, v43
    v_lshlrev_b32 v40, 16, v26
    v_and_b32 v41, 0xffff0000, v26
    v_mul_f32 v40, s29, v40
    v_mul_f32 v41, s29, v41
    v_cvt_pk_bf16_f32 v26, v40, v41
    v_lshlrev_b32 v42, 16, v27
    v_and_b32 v43, 0xffff0000, v27
    v_mul_f32 v42, s29, v42
    v_mul_f32 v43, s29, v43
    v_cvt_pk_bf16_f32 v27, v42, v43
    ds_write_b128 v214, v[24:27] offset:2048
    v_lshlrev_b32 v40, 16, v28
    v_and_b32 v41, 0xffff0000, v28
    v_mul_f32 v40, s29, v40
    v_mul_f32 v41, s29, v41
    v_cvt_pk_bf16_f32 v28, v40, v41
    v_lshlrev_b32 v42, 16, v29
    v_and_b32 v43, 0xffff0000, v29
    v_mul_f32 v42, s29, v42
    v_mul_f32 v43, s29, v43
    v_cvt_pk_bf16_f32 v29, v42, v43
    v_lshlrev_b32 v40, 16, v30
    v_and_b32 v41, 0xffff0000, v30
    v_mul_f32 v40, s29, v40
    v_mul_f32 v41, s29, v41
    v_cvt_pk_bf16_f32 v30, v40, v41
    v_lshlrev_b32 v42, 16, v31
    v_and_b32 v43, 0xffff0000, v31
    v_mul_f32 v42, s29, v42
    v_mul_f32 v43, s29, v43
    v_cvt_pk_bf16_f32 v31, v42, v43
    ds_write_b128 v215, v[28:31] offset:3072
    v_lshlrev_b32 v40, 16, v32
    v_and_b32 v41, 0xffff0000, v32
    v_mul_f32 v40, s29, v40
    v_mul_f32 v41, s29, v41
    v_cvt_pk_bf16_f32 v32, v40, v41
    v_lshlrev_b32 v42, 16, v33
    v_and_b32 v43, 0xffff0000, v33
    v_mul_f32 v42, s29, v42
    v_mul_f32 v43, s29, v43
    v_cvt_pk_bf16_f32 v33, v42, v43
    v_lshlrev_b32 v40, 16, v34
    v_and_b32 v41, 0xffff0000, v34
    v_mul_f32 v40, s29, v40
    v_mul_f32 v41, s29, v41
    v_cvt_pk_bf16_f32 v34, v40, v41
    v_lshlrev_b32 v42, 16, v35
    v_and_b32 v43, 0xffff0000, v35
    v_mul_f32 v42, s29, v42
    v_mul_f32 v43, s29, v43
    v_cvt_pk_bf16_f32 v35, v42, v43
    ds_write_b128 v212, v[32:35] offset:4096
    v_lshlrev_b32 v40, 16, v36
    v_and_b32 v41, 0xffff0000, v36
    v_mul_f32 v40, s29, v40
    v_mul_f32 v41, s29, v41
    v_cvt_pk_bf16_f32 v36, v40, v41
    v_lshlrev_b32 v42, 16, v37
    v_and_b32 v43, 0xffff0000, v37
    v_mul_f32 v42, s29, v42
    v_mul_f32 v43, s29, v43
    v_cvt_pk_bf16_f32 v37, v42, v43
    v_lshlrev_b32 v40, 16, v38
    v_and_b32 v41, 0xffff0000, v38
    v_mul_f32 v40, s29, v40
    v_mul_f32 v41, s29, v41
    v_cvt_pk_bf16_f32 v38, v40, v41
    v_lshlrev_b32 v42, 16, v39
    v_and_b32 v43, 0xffff0000, v39
    v_mul_f32 v42, s29, v42
    v_mul_f32 v43, s29, v43
    v_cvt_pk_bf16_f32 v39, v42, v43
    ds_write_b128 v213, v[36:39] offset:5120
    s_add_u32 s46, s30, 1
    s_and_b32 s46, s46, 15
    s_lshl_b32 s36, s46, 15
    s_add_u32 s37, s36, 4096
    s_add_u32 m0, s39, 8192
    s_nop 0
    buffer_load_dwordx4 v236, s[16:19], s36 offen offset:0 nt lds
    buffer_load_dwordx4 v237, s[16:19], s36 offen offset:1024 nt lds
    buffer_load_dwordx4 v238, s[16:19], s36 offen offset:2048 nt lds
    buffer_load_dwordx4 v239, s[16:19], s36 offen offset:3072 nt lds
    s_waitcnt lgkmcnt(0)
    s_barrier
    ds_read_b128 a[192:195], v10
    v_xor_b32 v217, 32, v10
    ds_read_b128 a[196:199], v217
    v_xor_b32 v218, 64, v10
    ds_read_b128 a[200:203], v218
    v_xor_b32 v219, 96, v10
    ds_read_b128 a[204:207], v219
    s_add_u32 m0, s39, 12288
    s_nop 0
    buffer_load_dwordx4 v236, s[16:19], s37 offen offset:0 nt lds
    v_xor_b32 v216, 128, v10
    ds_read_b128 a[208:211], v216
    v_xor_b32 v217, 160, v10
    ds_read_b128 a[212:215], v217
    v_xor_b32 v218, 192, v10
    ds_read_b128 a[216:219], v218
    v_xor_b32 v219, 224, v10
    ds_read_b128 a[220:223], v219
    buffer_load_dwordx4 v237, s[16:19], s37 offen offset:1024 nt lds
    ds_read_b128 a[224:227], v11
    v_xor_b32 v217, 32, v11
    ds_read_b128 a[228:231], v217
    v_xor_b32 v218, 64, v11
    ds_read_b128 a[232:235], v218
    v_xor_b32 v219, 96, v11
    ds_read_b128 a[236:239], v219
    buffer_load_dwordx4 v238, s[16:19], s37 offen offset:2048 nt lds
    v_xor_b32 v216, 128, v11
    ds_read_b128 a[240:243], v216
    v_xor_b32 v217, 160, v11
    ds_read_b128 a[244:247], v217
    v_xor_b32 v218, 192, v11
    ds_read_b128 a[248:251], v218
    v_xor_b32 v219, 224, v11
    ds_read_b128 a[252:255], v219
    buffer_load_dwordx4 v239, s[16:19], s37 offen offset:3072 nt lds
    ds_read_b128 v[152:155], v12
    v_xor_b32 v217, 32, v12
    ds_read_b128 v[156:159], v217
    v_xor_b32 v218, 64, v12
    ds_read_b128 v[160:163], v218
    v_xor_b32 v219, 96, v12
    ds_read_b128 v[164:167], v219
    v_xor_b32 v216, 128, v12
    ds_read_b128 v[168:171], v216
    v_xor_b32 v217, 160, v12
    ds_read_b128 v[172:175], v217
    v_xor_b32 v218, 192, v12
    ds_read_b128 v[176:179], v218
    v_xor_b32 v219, 224, v12
    ds_read_b128 v[180:183], v219
    s_waitcnt vmcnt(16)
    ds_read_b128 v[88:91], v220 offset:0
    ds_read_b128 v[92:95], v221 offset:0
    ds_read_b128 v[96:99], v222 offset:0
    ds_read_b128 v[100:103], v223 offset:0
    ds_read_b128 v[104:107], v224 offset:0
    ds_read_b128 v[108:111], v225 offset:0
    ds_read_b128 v[112:115], v226 offset:0
    ds_read_b128 v[116:119], v227 offset:0
    s_mov_b32 s34, s36
    s_mov_b32 s35, s37
    s_add_u32 m0, s39, 24576
    s_nop 0
    buffer_load_dwordx4 v236, s[20:23], s34 offen offset:0 nt lds
    buffer_load_dwordx4 v237, s[20:23], s34 offen offset:1024 nt lds
    buffer_load_dwordx4 v238, s[20:23], s34 offen offset:2048 nt lds
    buffer_load_dwordx4 v239, s[20:23], s34 offen offset:3072 nt lds
    s_add_u32 m0, s39, 28672
    s_nop 0
    buffer_load_dwordx4 v236, s[20:23], s35 offen offset:0 nt lds
    buffer_load_dwordx4 v237, s[20:23], s35 offen offset:1024 nt lds
    buffer_load_dwordx4 v238, s[20:23], s35 offen offset:2048 nt lds
    buffer_load_dwordx4 v239, s[20:23], s35 offen offset:3072 nt lds
    s_waitcnt lgkmcnt(0)
    s_add_u32 s46, s30, 2
    s_and_b32 s46, s46, 15
    s_lshl_b32 s36, s46, 15
    v_mfma_f32_32x32x16_bf16 v[16:31], v[196:199], v[184:187], 0
    v_mfma_f32_32x32x16_bf16 v[16:31], v[88:91], a[192:195], v[16:31]
    s_add_u32 m0, s39, 0
    s_nop 0
    buffer_load_dwordx4 v236, s[16:19], s36 offen offset:0 nt lds
    v_mfma_f32_32x32x16_bf16 v[16:31], v[92:95], a[196:199], v[16:31]
    v_mfma_f32_32x32x16_bf16 v[16:31], v[96:99], a[200:203], v[16:31]
    buffer_load_dwordx4 v237, s[16:19], s36 offen offset:1024 nt lds
    v_mfma_f32_32x32x16_bf16 v[16:31], v[100:103], a[204:207], v[16:31]
    v_mfma_f32_32x32x16_bf16 v[16:31], v[104:107], a[208:211], v[16:31]
    buffer_load_dwordx4 v238, s[16:19], s36 offen offset:2048 nt lds
    v_mfma_f32_32x32x16_bf16 v[16:31], v[108:111], a[212:215], v[16:31]
    v_mfma_f32_32x32x16_bf16 v[16:31], v[112:115], a[216:219], v[16:31]
    buffer_load_dwordx4 v239, s[16:19], s36 offen offset:3072 nt lds
    v_mfma_f32_32x32x16_bf16 v[16:31], v[116:119], a[220:223], v[16:31]
    s_nop 15
    s_mov_b32 s31, 0
    s_mov_b32 s34, s36
    s_add_u32 s35, s34, 4096
    s_mov_b32 s37, s35
    s_add_u32 s46, s30, 3
    s_and_b32 s46, s46, 15
    s_lshl_b32 s36, s46, 15
LOOP:
    v_mfma_f32_32x32x16_bf16 v[32:47], v[196:199], v[188:191], 0
    v_max3_f32 v212, v16, v17, v18
    v_max3_f32 v213, v19, v20, v21
    v_max3_f32 v212, v212, v22, v23
    v_max3_f32 v213, v213, v24, v25
    v_max3_f32 v212, v212, v26, v27
    v_mfma_f32_32x32x16_bf16 v[32:47], v[88:91], a[224:227], v[32:47]
    s_add_u32 m0, s39, 4096
    s_nop 0
    buffer_load_dwordx4 v236, s[16:19], s37 offen offset:0 nt lds
    v_max3_f32 v213, v213, v28, v29
    v_max3_f32 v212, v212, v30, v31
    v_mfma_f32_32x32x16_bf16 v[32:47], v[92:95], a[228:231], v[32:47]
    v_max_f32 v212, v212, v213
    v_cmp_gt_f32 vcc, v212, v206
    s_cbranch_vccnz RARE_0_0
BACK_0_0:
    v_exp_f32 v16, v16
    v_exp_f32 v17, v17
    v_mfma_f32_32x32x16_bf16 v[32:47], v[96:99], a[232:235], v[32:47]
    buffer_load_dwordx4 v237, s[16:19], s37 offen offset:1024 nt lds
    v_exp_f32 v18, v18
    v_add_f32 v209, v209, v16
    v_mfma_f32_32x32x16_bf16 v[32:47], v[100:103], a[236:239], v[32:47]
    v_exp_f32 v19, v19
    v_add_f32 v209, v209, v17
    v_cvt_pk_bf16_f32 v64, v16, v17
    v_exp_f32 v20, v20
    v_mfma_f32_32x32x16_bf16 v[32:47], v[104:107], a[240:243], v[32:47]
    buffer_load_dwordx4 v238, s[16:19], s37 offen offset:2048 nt lds
    v_add_f32 v209, v209, v18
    v_exp_f32 v21, v21
    v_mfma_f32_32x32x16_bf16 v[32:47], v[108:111], a[244:247], v[32:47]
    v_add_f32 v209, v209, v19
    v_cvt_pk_bf16_f32 v65, v18, v19
    v_exp_f32 v22, v22
    v_add_f32 v209, v209, v20
    v_mfma_f32_32x32x16_bf16 v[32:47], v[112:115], a[248:251], v[32:47]
    buffer_load_dwordx4 v239, s[16:19], s37 offen offset:3072 nt lds
    v_exp_f32 v23, v23
    v_add_f32 v209, v209, v21
    v_mfma_f32_32x32x16_bf16 v[32:47], v[116:119], a[252:255], v[32:47]
    v_cvt_pk_bf16_f32 v66, v20, v21
    v_exp_f32 v24, v24
    v_add_f32 v209, v209, v22
    v_exp_f32 v25, v25
    s_waitcnt vmcnt(24)
    v_mfma_f32_32x32x16_bf16 a[128:143], v[120:123], v[80:83], a[128:143]
    ds_read_b64_tr_b16 v[120:121], v228 offset:16384
    ds_read_b64_tr_b16 v[122:123], v229 offset:18432
    v_add_f32 v209, v209, v23
    v_cvt_pk_bf16_f32 v67, v22, v23
    v_mfma_f32_32x32x16_bf16 a[144:159], v[128:131], v[80:83], a[144:159]
    ds_read_b64_tr_b16 v[128:129], v230 offset:16384
    ds_read_b64_tr_b16 v[130:131], v231 offset:18432
    v_exp_f32 v26, v26
    v_add_f32 v209, v209, v24
    v_mfma_f32_32x32x16_bf16 a[160:175], v[136:139], v[80:83], a[160:175]
    ds_read_b64_tr_b16 v[136:137], v232 offset:16384
    ds_read_b64_tr_b16 v[138:139], v233 offset:18432
    v_exp_f32 v27, v27
    v_add_f32 v209, v209, v25
    v_cvt_pk_bf16_f32 v68, v24, v25
    v_mfma_f32_32x32x16_bf16 a[176:191], v[144:147], v[80:83], a[176:191]
    ds_read_b64_tr_b16 v[144:145], v234 offset:16384
    ds_read_b64_tr_b16 v[146:147], v235 offset:18432
    v_exp_f32 v28, v28
    v_add_f32 v209, v209, v26
    v_mfma_f32_32x32x16_bf16 a[128:143], v[124:127], v[84:87], a[128:143]
    ds_read_b64_tr_b16 v[124:125], v228 offset:20480
    ds_read_b64_tr_b16 v[126:127], v229 offset:22528
    v_exp_f32 v29, v29
    v_add_f32 v209, v209, v27
    v_cvt_pk_bf16_f32 v69, v26, v27
    v_mfma_f32_32x32x16_bf16 a[144:159], v[132:135], v[84:87], a[144:159]
    ds_read_b64_tr_b16 v[132:133], v230 offset:20480
    ds_read_b64_tr_b16 v[134:135], v231 offset:22528
    v_exp_f32 v30, v30
    v_add_f32 v209, v209, v28
    v_mfma_f32_32x32x16_bf16 a[160:175], v[140:143], v[84:87], a[160:175]
    ds_read_b64_tr_b16 v[140:141], v232 offset:20480
    ds_read_b64_tr_b16 v[142:143], v233 offset:22528
    v_exp_f32 v31, v31
    v_add_f32 v209, v209, v29
    v_cvt_pk_bf16_f32 v70, v28, v29
    v_mfma_f32_32x32x16_bf16 a[176:191], v[148:151], v[84:87], a[176:191]
    ds_read_b64_tr_b16 v[148:149], v234 offset:20480
    ds_read_b64_tr_b16 v[150:151], v235 offset:22528
    v_add_f32 v209, v209, v30
    v_add_f32 v209, v209, v31
    v_cvt_pk_bf16_f32 v71, v30, v31
    v_mfma_f32_32x32x16_bf16 v[48:63], v[196:199], v[192:195], 0
    v_max3_f32 v212, v32, v33, v34
    v_max3_f32 v213, v35, v36, v37
    v_max3_f32 v212, v212, v38, v39
    v_max3_f32 v213, v213, v40, v41
    v_max3_f32 v212, v212, v42, v43
    s_waitcnt vmcnt(16)
    v_mfma_f32_32x32x16_bf16 v[48:63], v[88:91], v[152:155], v[48:63]
    ds_read_b128 v[88:91], v220 offset:8192
    v_max3_f32 v213, v213, v44, v45
    v_max3_f32 v212, v212, v46, v47
    v_max_f32 v212, v212, v213
    v_cmp_gt_f32 vcc, v212, v207
    v_mfma_f32_32x32x16_bf16 v[48:63], v[92:95], v[156:159], v[48:63]
    ds_read_b128 v[92:95], v221 offset:8192
    s_cbranch_vccnz RARE_0_1
BACK_0_1:
    v_exp_f32 v32, v32
    v_exp_f32 v33, v33
    v_mfma_f32_32x32x16_bf16 v[48:63], v[96:99], v[160:163], v[48:63]
    ds_read_b128 v[96:99], v222 offset:8192
    v_exp_f32 v34, v34
    v_add_f32 v210, v210, v32
    v_mfma_f32_32x32x16_bf16 v[48:63], v[100:103], v[164:167], v[48:63]
    ds_read_b128 v[100:103], v223 offset:8192
    v_exp_f32 v35, v35
    v_add_f32 v210, v210, v33
    v_cvt_pk_bf16_f32 v72, v32, v33
    v_mfma_f32_32x32x16_bf16 v[48:63], v[104:107], v[168:171], v[48:63]
    ds_read_b128 v[104:107], v224 offset:8192
    v_exp_f32 v36, v36
    v_add_f32 v210, v210, v34
    v_mfma_f32_32x32x16_bf16 v[48:63], v[108:111], v[172:175], v[48:63]
    ds_read_b128 v[108:111], v225 offset:8192
    v_exp_f32 v37, v37
    v_add_f32 v210, v210, v35
    v_cvt_pk_bf16_f32 v73, v34, v35
    v_mfma_f32_32x32x16_bf16 v[48:63], v[112:115], v[176:179], v[48:63]
    ds_read_b128 v[112:115], v226 offset:8192
    v_exp_f32 v38, v38
    v_add_f32 v210, v210, v36
    v_exp_f32 v39, v39
    v_mfma_f32_32x32x16_bf16 v[48:63], v[116:119], v[180:183], v[48:63]
    ds_read_b128 v[116:119], v227 offset:8192
    v_add_f32 v210, v210, v37
    v_cvt_pk_bf16_f32 v74, v36, v37
    v_exp_f32 v40, v40
    s_waitcnt lgkmcnt(8)
    v_mfma_f32_32x32x16_bf16 a[0:15], v[120:123], v[64:67], a[0:15]
    s_add_u32 m0, s39, 16384
    s_nop 0
    buffer_load_dwordx4 v236, s[20:23], s34 offen offset:0 nt lds
    v_add_f32 v210, v210, v38
    v_mfma_f32_32x32x16_bf16 a[16:31], v[128:131], v[64:67], a[16:31]
    v_exp_f32 v41, v41
    v_add_f32 v210, v210, v39
    v_cvt_pk_bf16_f32 v75, v38, v39
    v_mfma_f32_32x32x16_bf16 a[32:47], v[136:139], v[64:67], a[32:47]
    buffer_load_dwordx4 v237, s[20:23], s34 offen offset:1024 nt lds
    v_exp_f32 v42, v42
    v_add_f32 v210, v210, v40
    v_mfma_f32_32x32x16_bf16 a[48:63], v[144:147], v[64:67], a[48:63]
    v_exp_f32 v43, v43
    v_add_f32 v210, v210, v41
    v_cvt_pk_bf16_f32 v76, v40, v41
    v_exp_f32 v44, v44
    v_mfma_f32_32x32x16_bf16 a[0:15], v[124:127], v[68:71], a[0:15]
    buffer_load_dwordx4 v238, s[20:23], s34 offen offset:2048 nt lds
    v_add_f32 v210, v210, v42
    v_exp_f32 v45, v45
    v_mfma_f32_32x32x16_bf16 a[16:31], v[132:135], v[68:71], a[16:31]
    v_add_f32 v210, v210, v43
    v_cvt_pk_bf16_f32 v77, v42, v43
    v_exp_f32 v46, v46
    v_mfma_f32_32x32x16_bf16 a[32:47], v[140:143], v[68:71], a[32:47]
    buffer_load_dwordx4 v239, s[20:23], s34 offen offset:3072 nt lds
    v_add_f32 v210, v210, v44
    v_exp_f32 v47, v47
    v_mfma_f32_32x32x16_bf16 a[48:63], v[148:151], v[68:71], a[48:63]
    v_add_f32 v210, v210, v45
    v_cvt_pk_bf16_f32 v78, v44, v45
    v_add_f32 v210, v210, v46
    v_add_f32 v210, v210, v47
    v_cvt_pk_bf16_f32 v79, v46, v47
    v_mfma_f32_32x32x16_bf16 v[16:31], v[196:199], v[184:187], 0
    v_max3_f32 v212, v48, v49, v50
    v_max3_f32 v213, v51, v52, v53
    v_max3_f32 v212, v212, v54, v55
    v_max3_f32 v213, v213, v56, v57
    v_max3_f32 v212, v212, v58, v59
    s_waitcnt lgkmcnt(0)
    v_mfma_f32_32x32x16_bf16 v[16:31], v[88:91], a[192:195], v[16:31]
    s_add_u32 m0, s39, 20480
    s_nop 0
    buffer_load_dwordx4 v236, s[20:23], s35 offen offset:0 nt lds
    v_max3_f32 v213, v213, v60, v61
    v_mfma_f32_32x32x16_bf16 v[16:31], v[92:95], a[196:199], v[16:31]
    v_max3_f32 v212, v212, v62, v63
    v_max_f32 v212, v212, v213
    v_cmp_gt_f32 vcc, v212, v208
    s_cbranch_vccnz RARE_0_2
BACK_0_2:
    v_exp_f32 v48, v48
    v_mfma_f32_32x32x16_bf16 v[16:31], v[96:99], a[200:203], v[16:31]
    buffer_load_dwordx4 v237, s[20:23], s35 offen offset:1024 nt lds
    v_exp_f32 v49, v49
    v_exp_f32 v50, v50
    v_mfma_f32_32x32x16_bf16 v[16:31], v[100:103], a[204:207], v[16:31]
    v_add_f32 v211, v211, v48
    v_exp_f32 v51, v51
    v_add_f32 v211, v211, v49
    v_mfma_f32_32x32x16_bf16 v[16:31], v[104:107], a[208:211], v[16:31]
    buffer_load_dwordx4 v238, s[20:23], s35 offen offset:2048 nt lds
    v_cvt_pk_bf16_f32 v80, v48, v49
    v_exp_f32 v52, v52
    v_mfma_f32_32x32x16_bf16 v[16:31], v[108:111], a[212:215], v[16:31]
    v_add_f32 v211, v211, v50
    v_exp_f32 v53, v53
    v_add_f32 v211, v211, v51
    v_cvt_pk_bf16_f32 v81, v50, v51
    v_mfma_f32_32x32x16_bf16 v[16:31], v[112:115], a[216:219], v[16:31]
    buffer_load_dwordx4 v239, s[20:23], s35 offen offset:3072 nt lds
    v_exp_f32 v54, v54
    v_add_f32 v211, v211, v52
    v_mfma_f32_32x32x16_bf16 v[16:31], v[116:119], a[220:223], v[16:31]
    v_exp_f32 v55, v55
    v_add_f32 v211, v211, v53
    v_cvt_pk_bf16_f32 v82, v52, v53
    v_mfma_f32_32x32x16_bf16 a[64:79], v[120:123], v[72:75], a[64:79]
    s_add_u32 m0, s39, 8192
    s_nop 0
    buffer_load_dwordx4 v236, s[16:19], s36 offen offset:0 nt lds
    v_exp_f32 v56, v56
    v_mfma_f32_32x32x16_bf16 a[80:95], v[128:131], v[72:75], a[80:95]
    v_add_f32 v211, v211, v54
    v_exp_f32 v57, v57
    v_add_f32 v211, v211, v55
    v_cvt_pk_bf16_f32 v83, v54, v55
    v_mfma_f32_32x32x16_bf16 a[96:111], v[136:139], v[72:75], a[96:111]
    buffer_load_dwordx4 v237, s[16:19], s36 offen offset:1024 nt lds
    v_exp_f32 v58, v58
    v_add_f32 v211, v211, v56
    v_mfma_f32_32x32x16_bf16 a[112:127], v[144:147], v[72:75], a[112:127]
    v_exp_f32 v59, v59
    v_add_f32 v211, v211, v57
    v_cvt_pk_bf16_f32 v84, v56, v57
    v_exp_f32 v60, v60
    v_mfma_f32_32x32x16_bf16 a[64:79], v[124:127], v[76:79], a[64:79]
    buffer_load_dwordx4 v238, s[16:19], s36 offen offset:2048 nt lds
    v_add_f32 v211, v211, v58
    v_exp_f32 v61, v61
    v_mfma_f32_32x32x16_bf16 a[80:95], v[132:135], v[76:79], a[80:95]
    v_add_f32 v211, v211, v59
    v_cvt_pk_bf16_f32 v85, v58, v59
    v_exp_f32 v62, v62
    v_mfma_f32_32x32x16_bf16 a[96:111], v[140:143], v[76:79], a[96:111]
    buffer_load_dwordx4 v239, s[16:19], s36 offen offset:3072 nt lds
    v_add_f32 v211, v211, v60
    v_exp_f32 v63, v63
    v_mfma_f32_32x32x16_bf16 a[112:127], v[148:151], v[76:79], a[112:127]
    v_add_f32 v211, v211, v61
    v_cvt_pk_bf16_f32 v86, v60, v61
    v_add_f32 v211, v211, v62
    v_add_f32 v211, v211, v63
    v_cvt_pk_bf16_f32 v87, v62, v63
    s_mov_b32 s34, s36
    s_add_u32 s35, s34, 4096
    s_mov_b32 s37, s35
    s_add_u32 s47, s31, 4
    s_add_u32 s46, s47, s30
    s_and_b32 s46, s46, 15
    s_lshl_b32 s46, s46, 15
    s_cmp_lt_u32 s47, 16
    s_cselect_b32 s36, s46, 0x7ff00000
    v_mfma_f32_32x32x16_bf16 v[32:47], v[196:199], v[188:191], 0
    v_max3_f32 v212, v16, v17, v18
    v_max3_f32 v213, v19, v20, v21
    v_max3_f32 v212, v212, v22, v23
    v_max3_f32 v213, v213, v24, v25
    v_max3_f32 v212, v212, v26, v27
    v_mfma_f32_32x32x16_bf16 v[32:47], v[88:91], a[224:227], v[32:47]
    s_add_u32 m0, s39, 12288
    s_nop 0
    buffer_load_dwordx4 v236, s[16:19], s37 offen offset:0 nt lds
    v_max3_f32 v213, v213, v28, v29
    v_max3_f32 v212, v212, v30, v31
    v_mfma_f32_32x32x16_bf16 v[32:47], v[92:95], a[228:231], v[32:47]
    v_max_f32 v212, v212, v213
    v_cmp_gt_f32 vcc, v212, v206
    s_cbranch_vccnz RARE_1_0
BACK_1_0:
    v_exp_f32 v16, v16
    v_exp_f32 v17, v17
    v_mfma_f32_32x32x16_bf16 v[32:47], v[96:99], a[232:235], v[32:47]
    buffer_load_dwordx4 v237, s[16:19], s37 offen offset:1024 nt lds
    v_exp_f32 v18, v18
    v_add_f32 v209, v209, v16
    v_mfma_f32_32x32x16_bf16 v[32:47], v[100:103], a[236:239], v[32:47]
    v_exp_f32 v19, v19
    v_add_f32 v209, v209, v17
    v_cvt_pk_bf16_f32 v64, v16, v17
    v_exp_f32 v20, v20
    v_mfma_f32_32x32x16_bf16 v[32:47], v[104:107], a[240:243], v[32:47]
    buffer_load_dwordx4 v238, s[16:19], s37 offen offset:2048 nt lds
    v_add_f32 v209, v209, v18
    v_exp_f32 v21, v21
    v_mfma_f32_32x32x16_bf16 v[32:47], v[108:111], a[244:247], v[32:47]
    v_add_f32 v209, v209, v19
    v_cvt_pk_bf16_f32 v65, v18, v19
    v_exp_f32 v22, v22
    v_add_f32 v209, v209, v20
    v_mfma_f32_32x32x16_bf16 v[32:47], v[112:115], a[248:251], v[32:47]
    buffer_load_dwordx4 v239, s[16:19], s37 offen offset:3072 nt lds
    v_exp_f32 v23, v23
    v_add_f32 v209, v209, v21
    v_mfma_f32_32x32x16_bf16 v[32:47], v[116:119], a[252:255], v[32:47]
    v_cvt_pk_bf16_f32 v66, v20, v21
    v_exp_f32 v24, v24
    v_add_f32 v209, v209, v22
    v_exp_f32 v25, v25
    s_waitcnt vmcnt(24)
    v_mfma_f32_32x32x16_bf16 a[128:143], v[120:123], v[80:83], a[128:143]
    ds_read_b64_tr_b16 v[120:121], v228 offset:24576
    ds_read_b64_tr_b16 v[122:123], v229 offset:26624
    v_add_f32 v209, v209, v23
    v_cvt_pk_bf16_f32 v67, v22, v23
    v_mfma_f32_32x32x16_bf16 a[144:159], v[128:131], v[80:83], a[144:159]
    ds_read_b64_tr_b16 v[128:129], v230 offset:24576
    ds_read_b64_tr_b16 v[130:131], v231 offset:26624
    v_exp_f32 v26, v26
    v_add_f32 v209, v209, v24
    v_mfma_f32_32x32x16_bf16 a[160:175], v[136:139], v[80:83], a[160:175]
    ds_read_b64_tr_b16 v[136:137], v232 offset:24576
    ds_read_b64_tr_b16 v[138:139], v233 offset:26624
    v_exp_f32 v27, v27
    v_add_f32 v209, v209, v25
    v_cvt_pk_bf16_f32 v68, v24, v25
    v_mfma_f32_32x32x16_bf16 a[176:191], v[144:147], v[80:83], a[176:191]
    ds_read_b64_tr_b16 v[144:145], v234 offset:24576
    ds_read_b64_tr_b16 v[146:147], v235 offset:26624
    v_exp_f32 v28, v28
    v_add_f32 v209, v209, v26
    v_mfma_f32_32x32x16_bf16 a[128:143], v[124:127], v[84:87], a[128:143]
    ds_read_b64_tr_b16 v[124:125], v228 offset:28672
    ds_read_b64_tr_b16 v[126:127], v229 offset:30720
    v_exp_f32 v29, v29
    v_add_f32 v209, v209, v27
    v_cvt_pk_bf16_f32 v69, v26, v27
    v_mfma_f32_32x32x16_bf16 a[144:159], v[132:135], v[84:87], a[144:159]
    ds_read_b64_tr_b16 v[132:133], v230 offset:28672
    ds_read_b64_tr_b16 v[134:135], v231 offset:30720
    v_exp_f32 v30, v30
    v_add_f32 v209, v209, v28
    v_mfma_f32_32x32x16_bf16 a[160:175], v[140:143], v[84:87], a[160:175]
    ds_read_b64_tr_b16 v[140:141], v232 offset:28672
    ds_read_b64_tr_b16 v[142:143], v233 offset:30720
    v_exp_f32 v31, v31
    v_add_f32 v209, v209, v29
    v_cvt_pk_bf16_f32 v70, v28, v29
    v_mfma_f32_32x32x16_bf16 a[176:191], v[148:151], v[84:87], a[176:191]
    ds_read_b64_tr_b16 v[148:149], v234 offset:28672
    ds_read_b64_tr_b16 v[150:151], v235 offset:30720
    v_add_f32 v209, v209, v30
    v_add_f32 v209, v209, v31
    v_cvt_pk_bf16_f32 v71, v30, v31
    v_mfma_f32_32x32x16_bf16 v[48:63], v[196:199], v[192:195], 0
    v_max3_f32 v212, v32, v33, v34
    v_max3_f32 v213, v35, v36, v37
    v_max3_f32 v212, v212, v38, v39
    v_max3_f32 v213, v213, v40, v41
    v_max3_f32 v212, v212, v42, v43
    s_waitcnt vmcnt(16)
    v_mfma_f32_32x32x16_bf16 v[48:63], v[88:91], v[152:155], v[48:63]
    ds_read_b128 v[88:91], v220 offset:0
    v_max3_f32 v213, v213, v44, v45
    v_max3_f32 v212, v212, v46, v47
    v_max_f32 v212, v212, v213
    v_cmp_gt_f32 vcc, v212, v207
    v_mfma_f32_32x32x16_bf16 v[48:63], v[92:95], v[156:159], v[48:63]
    ds_read_b128 v[92:95], v221 offset:0
    s_cbranch_vccnz RARE_1_1
BACK_1_1:
    v_exp_f32 v32, v32
    v_exp_f32 v33, v33
    v_mfma_f32_32x32x16_bf16 v[48:63], v[96:99], v[160:163], v[48:63]
    ds_read_b128 v[96:99], v222 offset:0
    v_exp_f32 v34, v34
    v_add_f32 v210, v210, v32
    v_mfma_f32_32x32x16_bf16 v[48:63], v[100:103], v[164:167], v[48:63]
    ds_read_b128 v[100:103], v223 offset:0
    v_exp_f32 v35, v35
    v_add_f32 v210, v210, v33
    v_cvt_pk_bf16_f32 v72, v32, v33
    v_mfma_f32_32x32x16_bf16 v[48:63], v[104:107], v[168:171], v[48:63]
    ds_read_b128 v[104:107], v224 offset:0
    v_exp_f32 v36, v36
    v_add_f32 v210, v210, v34
    v_mfma_f32_32x32x16_bf16 v[48:63], v[108:111], v[172:175], v[48:63]
    ds_read_b128 v[108:111], v225 offset:0
    v_exp_f32 v37, v37
    v_add_f32 v210, v210, v35
    v_cvt_pk_bf16_f32 v73, v34, v35
    v_mfma_f32_32x32x16_bf16 v[48:63], v[112:115], v[176:179], v[48:63]
    ds_read_b128 v[112:115], v226 offset:0
    v_exp_f32 v38, v38
    v_add_f32 v210, v210, v36
    v_exp_f32 v39, v39
    v_mfma_f32_32x32x16_bf16 v[48:63], v[116:119], v[180:183], v[48:63]
    ds_read_b128 v[116:119], v227 offset:0
    v_add_f32 v210, v210, v37
    v_cvt_pk_bf16_f32 v74, v36, v37
    v_exp_f32 v40, v40
    s_waitcnt lgkmcnt(8)
    v_mfma_f32_32x32x16_bf16 a[0:15], v[120:123], v[64:67], a[0:15]
    s_add_u32 m0, s39, 24576
    s_nop 0
    buffer_load_dwordx4 v236, s[20:23], s34 offen offset:0 nt lds
    v_add_f32 v210, v210, v38
    v_mfma_f32_32x32x16_bf16 a[16:31], v[128:131], v[64:67], a[16:31]
    v_exp_f32 v41, v41
    v_add_f32 v210, v210, v39
    v_cvt_pk_bf16_f32 v75, v38, v39
    v_mfma_f32_32x32x16_bf16 a[32:47], v[136:139], v[64:67], a[32:47]
    buffer_load_dwordx4 v237, s[20:23], s34 offen offset:1024 nt lds
    v_exp_f32 v42, v42
    v_add_f32 v210, v210, v40
    v_mfma_f32_32x32x16_bf16 a[48:63], v[144:147], v[64:67], a[48:63]
    v_exp_f32 v43, v43
    v_add_f32 v210, v210, v41
    v_cvt_pk_bf16_f32 v76, v40, v41
    v_exp_f32 v44, v44
    v_mfma_f32_32x32x16_bf16 a[0:15], v[124:127], v[68:71], a[0:15]
    buffer_load_dwordx4 v238, s[20:23], s34 offen offset:2048 nt lds
    v_add_f32 v210, v210, v42
    v_exp_f32 v45, v45
    v_mfma_f32_32x32x16_bf16 a[16:31], v[132:135], v[68:71], a[16:31]
    v_add_f32 v210, v210, v43
    v_cvt_pk_bf16_f32 v77, v42, v43
    v_exp_f32 v46, v46
    v_mfma_f32_32x32x16_bf16 a[32:47], v[140:143], v[68:71], a[32:47]
    buffer_load_dwordx4 v239, s[20:23], s34 offen offset:3072 nt lds
    v_add_f32 v210, v210, v44
    v_exp_f32 v47, v47
    v_mfma_f32_32x32x16_bf16 a[48:63], v[148:151], v[68:71], a[48:63]
    v_add_f32 v210, v210, v45
    v_cvt_pk_bf16_f32 v78, v44, v45
    v_add_f32 v210, v210, v46
    v_add_f32 v210, v210, v47
    v_cvt_pk_bf16_f32 v79, v46, v47
    v_mfma_f32_32x32x16_bf16 v[16:31], v[196:199], v[184:187], 0
    v_max3_f32 v212, v48, v49, v50
    v_max3_f32 v213, v51, v52, v53
    v_max3_f32 v212, v212, v54, v55
    v_max3_f32 v213, v213, v56, v57
    v_max3_f32 v212, v212, v58, v59
    s_waitcnt lgkmcnt(0)
    v_mfma_f32_32x32x16_bf16 v[16:31], v[88:91], a[192:195], v[16:31]
    s_add_u32 m0, s39, 28672
    s_nop 0
    buffer_load_dwordx4 v236, s[20:23], s35 offen offset:0 nt lds
    v_max3_f32 v213, v213, v60, v61
    v_mfma_f32_32x32x16_bf16 v[16:31], v[92:95], a[196:199], v[16:31]
    v_max3_f32 v212, v212, v62, v63
    v_max_f32 v212, v212, v213
    v_cmp_gt_f32 vcc, v212, v208
    s_cbranch_vccnz RARE_1_2
BACK_1_2:
    v_exp_f32 v48, v48
    v_mfma_f32_32x32x16_bf16 v[16:31], v[96:99], a[200:203], v[16:31]
    buffer_load_dwordx4 v237, s[20:23], s35 offen offset:1024 nt lds
    v_exp_f32 v49, v49
    v_exp_f32 v50, v50
    v_mfma_f32_32x32x16_bf16 v[16:31], v[100:103], a[204:207], v[16:31]
    v_add_f32 v211, v211, v48
    v_exp_f32 v51, v51
    v_add_f32 v211, v211, v49
    v_mfma_f32_32x32x16_bf16 v[16:31], v[104:107], a[208:211], v[16:31]
    buffer_load_dwordx4 v238, s[20:23], s35 offen offset:2048 nt lds
    v_cvt_pk_bf16_f32 v80, v48, v49
    v_exp_f32 v52, v52
    v_mfma_f32_32x32x16_bf16 v[16:31], v[108:111], a[212:215], v[16:31]
    v_add_f32 v211, v211, v50
    v_exp_f32 v53, v53
    v_add_f32 v211, v211, v51
    v_cvt_pk_bf16_f32 v81, v50, v51
    v_mfma_f32_32x32x16_bf16 v[16:31], v[112:115], a[216:219], v[16:31]
    buffer_load_dwordx4 v239, s[20:23], s35 offen offset:3072 nt lds
    v_exp_f32 v54, v54
    v_add_f32 v211, v211, v52
    v_mfma_f32_32x32x16_bf16 v[16:31], v[116:119], a[220:223], v[16:31]
    v_exp_f32 v55, v55
    v_add_f32 v211, v211, v53
    v_cvt_pk_bf16_f32 v82, v52, v53
    v_mfma_f32_32x32x16_bf16 a[64:79], v[120:123], v[72:75], a[64:79]
    s_add_u32 m0, s39, 0
    s_nop 0
    buffer_load_dwordx4 v236, s[16:19], s36 offen offset:0 nt lds
    v_exp_f32 v56, v56
    v_mfma_f32_32x32x16_bf16 a[80:95], v[128:131], v[72:75], a[80:95]
    v_add_f32 v211, v211, v54
    v_exp_f32 v57, v57
    v_add_f32 v211, v211, v55
    v_cvt_pk_bf16_f32 v83, v54, v55
    v_mfma_f32_32x32x16_bf16 a[96:111], v[136:139], v[72:75], a[96:111]
    buffer_load_dwordx4 v237, s[16:19], s36 offen offset:1024 nt lds
    v_exp_f32 v58, v58
    v_add_f32 v211, v211, v56
    v_mfma_f32_32x32x16_bf16 a[112:127], v[144:147], v[72:75], a[112:127]
    v_exp_f32 v59, v59
    v_add_f32 v211, v211, v57
    v_cvt_pk_bf16_f32 v84, v56, v57
    v_exp_f32 v60, v60
    v_mfma_f32_32x32x16_bf16 a[64:79], v[124:127], v[76:79], a[64:79]
    buffer_load_dwordx4 v238, s[16:19], s36 offen offset:2048 nt lds
    v_add_f32 v211, v211, v58
    v_exp_f32 v61, v61
    v_mfma_f32_32x32x16_bf16 a[80:95], v[132:135], v[76:79], a[80:95]
    v_add_f32 v211, v211, v59
    v_cvt_pk_bf16_f32 v85, v58, v59
    v_exp_f32 v62, v62
    v_mfma_f32_32x32x16_bf16 a[96:111], v[140:143], v[76:79], a[96:111]
    buffer_load_dwordx4 v239, s[16:19], s36 offen offset:3072 nt lds
    v_add_f32 v211, v211, v60
    v_exp_f32 v63, v63
    v_mfma_f32_32x32x16_bf16 a[112:127], v[148:151], v[76:79], a[112:127]
    v_add_f32 v211, v211, v61
    v_cvt_pk_bf16_f32 v86, v60, v61
    v_add_f32 v211, v211, v62
    v_add_f32 v211, v211, v63
    v_cvt_pk_bf16_f32 v87, v62, v63
    s_mov_b32 s34, s36
    s_add_u32 s35, s34, 4096
    s_mov_b32 s37, s35
    s_add_u32 s47, s31, 5
    s_add_u32 s46, s47, s30
    s_and_b32 s46, s46, 15
    s_lshl_b32 s46, s46, 15
    s_cmp_lt_u32 s47, 16
    s_cselect_b32 s36, s46, 0x7ff00000
    s_add_u32 s31, s31, 2
    s_cmp_lt_u32 s31, 16
    s_cbranch_scc1 LOOP
    s_waitcnt vmcnt(0) lgkmcnt(0)
    v_mfma_f32_32x32x16_bf16 a[128:143], v[120:123], v[80:83], a[128:143]
    v_mfma_f32_32x32x16_bf16 a[144:159], v[128:131], v[80:83], a[144:159]
    v_mfma_f32_32x32x16_bf16 a[160:175], v[136:139], v[80:83], a[160:175]
    v_mfma_f32_32x32x16_bf16 a[176:191], v[144:147], v[80:83], a[176:191]
    v_mfma_f32_32x32x16_bf16 a[128:143], v[124:127], v[84:87], a[128:143]
    v_mfma_f32_32x32x16_bf16 a[144:159], v[132:135], v[84:87], a[144:159]
    v_mfma_f32_32x32x16_bf16 a[160:175], v[140:143], v[84:87], a[160:175]
    v_mfma_f32_32x32x16_bf16 a[176:191], v[148:151], v[84:87], a[176:191]
    v_mov_b32 v212, v209
    s_nop 1
    v_permlane32_swap_b32 v209, v212
    v_add_f32 v209, v209, v212
    v_mov_b32 v212, v210
    s_nop 1
    v_permlane32_swap_b32 v210, v212
    v_add_f32 v210, v210, v212
    v_mov_b32 v212, v211
    s_nop 1
    v_permlane32_swap_b32 v211, v212
    v_add_f32 v211, v211, v212
    v_and_b32 v3, 31, v240
    v_lshlrev_b32 v4, 3, v3
    v_add_u32 v5, s39, v4
    v_mov_b32 v212, v203
    v_mov_b32 v213, v209
    ds_write_b64 v5, v[212:213] offset:0
    v_mov_b32 v212, v204
    v_mov_b32 v213, v210
    ds_write_b64 v5, v[212:213] offset:256
    v_mov_b32 v212, v205
    v_mov_b32 v213, v211
    ds_write_b64 v5, v[212:213] offset:512
    v_lshlrev_b32 v6, 4, v240
    v_add_u32 v7, s39, v6
    s_cmp_eq_u32 s28, 0
    s_cbranch_scc1 EPI_0
    s_cmp_eq_u32 s28, 1
    s_cbranch_scc1 EPI_1
    s_cmp_eq_u32 s28, 2
    s_cbranch_scc1 EPI_2
    s_branch EPI_3
EPI_0:
    ds_write_b128 v7, a[16:19] offset:1024
    ds_write_b128 v7, a[20:23] offset:2048
    ds_write_b128 v7, a[24:27] offset:3072
    ds_write_b128 v7, a[28:31] offset:4096
    ds_write_b128 v7, a[32:35] offset:13312
    ds_write_b128 v7, a[36:39] offset:14336
    ds_write_b128 v7, a[40:43] offset:15360
    ds_write_b128 v7, a[44:47] offset:16384
    ds_write_b128 v7, a[48:51] offset:25600
    ds_write_b128 v7, a[52:55] offset:26624
    ds_write_b128 v7, a[56:59] offset:27648
    ds_write_b128 v7, a[60:63] offset:28672
    v_accvgpr_read_b32 v16, a0
    v_accvgpr_read_b32 v17, a1
    v_accvgpr_read_b32 v18, a2
    v_accvgpr_read_b32 v19, a3
    v_accvgpr_read_b32 v20, a4
    v_accvgpr_read_b32 v21, a5
    v_accvgpr_read_b32 v22, a6
    v_accvgpr_read_b32 v23, a7
    v_accvgpr_read_b32 v24, a8
    v_accvgpr_read_b32 v25, a9
    v_accvgpr_read_b32 v26, a10
    v_accvgpr_read_b32 v27, a11
    v_accvgpr_read_b32 v28, a12
    v_accvgpr_read_b32 v29, a13
    v_accvgpr_read_b32 v30, a14
    v_accvgpr_read_b32 v31, a15
    ds_write_b128 v7, a[80:83] offset:5120
    ds_write_b128 v7, a[84:87] offset:6144
    ds_write_b128 v7, a[88:91] offset:7168
    ds_write_b128 v7, a[92:95] offset:8192
    ds_write_b128 v7, a[96:99] offset:17408
    ds_write_b128 v7, a[100:103] offset:18432
    ds_write_b128 v7, a[104:107] offset:19456
    ds_write_b128 v7, a[108:111] offset:20480
    ds_write_b128 v7, a[112:115] offset:29696
    ds_write_b128 v7, a[116:119] offset:30720
    ds_write_b128 v7, a[120:123] offset:31744
    ds_write_b128 v7, a[124:127] offset:32768
    v_accvgpr_read_b32 v32, a64
    v_accvgpr_read_b32 v33, a65
    v_accvgpr_read_b32 v34, a66
    v_accvgpr_read_b32 v35, a67
    v_accvgpr_read_b32 v36, a68
    v_accvgpr_read_b32 v37, a69
    v_accvgpr_read_b32 v38, a70
    v_accvgpr_read_b32 v39, a71
    v_accvgpr_read_b32 v40, a72
    v_accvgpr_read_b32 v41, a73
    v_accvgpr_read_b32 v42, a74
    v_accvgpr_read_b32 v43, a75
    v_accvgpr_read_b32 v44, a76
    v_accvgpr_read_b32 v45, a77
    v_accvgpr_read_b32 v46, a78
    v_accvgpr_read_b32 v47, a79
    s_nop 7
    ds_write_b128 v7, a[144:147] offset:9216
    ds_write_b128 v7, a[148:151] offset:10240
    ds_write_b128 v7, a[152:155] offset:11264
    ds_write_b128 v7, a[156:159] offset:12288
    ds_write_b128 v7, a[160:163] offset:21504
    ds_write_b128 v7, a[164:167] offset:22528
    ds_write_b128 v7, a[168:171] offset:23552
    ds_write_b128 v7, a[172:175] offset:24576
    ds_write_b128 v7, a[176:179] offset:33792
    ds_write_b128 v7, a[180:183] offset:34816
    ds_write_b128 v7, a[184:187] offset:35840
    ds_write_b128 v7, a[188:191] offset:36864
    v_accvgpr_read_b32 v48, a128
    v_accvgpr_read_b32 v49, a129
    v_accvgpr_read_b32 v50, a130
    v_accvgpr_read_b32 v51, a131
    v_accvgpr_read_b32 v52, a132
    v_accvgpr_read_b32 v53, a133
    v_accvgpr_read_b32 v54, a134
    v_accvgpr_read_b32 v55, a135
    v_accvgpr_read_b32 v56, a136
    v_accvgpr_read_b32 v57, a137
    v_accvgpr_read_b32 v58, a138
    v_accvgpr_read_b32 v59, a139
    v_accvgpr_read_b32 v60, a140
    v_accvgpr_read_b32 v61, a141
    v_accvgpr_read_b32 v62, a142
    v_accvgpr_read_b32 v63, a143
    s_waitcnt lgkmcnt(0)
    s_barrier
    ds_read_b64 v[160:161], v4 offset:0
    ds_read_b64 v[162:163], v4 offset:40960
    v_add_u32 v8, 81920, v4
    ds_read_b64 v[164:165], v8 offset:0
    v_add_u32 v8, 122880, v4
    ds_read_b64 v[166:167], v8 offset:0
    ds_read_b64 v[168:169], v4 offset:256
    ds_read_b64 v[170:171], v4 offset:41216
    v_add_u32 v8, 81920, v4
    ds_read_b64 v[172:173], v8 offset:256
    v_add_u32 v8, 122880, v4
    ds_read_b64 v[174:175], v8 offset:256
    ds_read_b64 v[176:177], v4 offset:512
    ds_read_b64 v[178:179], v4 offset:41472
    v_add_u32 v8, 81920, v4
    ds_read_b64 v[180:181], v8 offset:512
    v_add_u32 v8, 122880, v4
    ds_read_b64 v[182:183], v8 offset:512
    v_add_u32 v9, 40960, v6
    v_add_u32 v10, 81920, v6
    v_add_u32 v11, 122880, v6
    ds_read_b128 v[64:67], v9 offset:1024
    ds_read_b128 v[68:71], v9 offset:2048
    ds_read_b128 v[72:75], v9 offset:3072
    ds_read_b128 v[76:79], v9 offset:4096
    ds_read_b128 v[80:83], v9 offset:5120
    ds_read_b128 v[84:87], v9 offset:6144
    ds_read_b128 v[88:91], v9 offset:7168
    ds_read_b128 v[92:95], v9 offset:8192
    ds_read_b128 v[96:99], v9 offset:9216
    ds_read_b128 v[100:103], v9 offset:10240
    ds_read_b128 v[104:107], v9 offset:11264
    ds_read_b128 v[108:111], v9 offset:12288
    s_waitcnt lgkmcnt(12)
    v_max_f32 v212, v160, v162
    v_max3_f32 v212, v212, v164, v166
    v_sub_f32 v160, v160, v212
    v_exp_f32 v160, v160
    v_sub_f32 v162, v162, v212
    v_exp_f32 v162, v162
    v_sub_f32 v164, v164, v212
    v_exp_f32 v164, v164
    v_sub_f32 v166, v166, v212
    v_exp_f32 v166, v166
    s_nop 0
    v_mul_f32 v213, v160, v161
    v_fmac_f32 v213, v162, v163
    v_fmac_f32 v213, v164, v165
    v_fmac_f32 v213, v166, v167
    v_rcp_f32 v213, v213
    s_nop 0
    v_mul_f32 v160, v160, v213
    v_mul_f32 v162, v162, v213
    v_mul_f32 v164, v164, v213
    v_mul_f32 v166, v166, v213
    v_max_f32 v212, v168, v170
    v_max3_f32 v212, v212, v172, v174
    v_sub_f32 v168, v168, v212
    v_exp_f32 v168, v168
    v_sub_f32 v170, v170, v212
    v_exp_f32 v170, v170
    v_sub_f32 v172, v172, v212
    v_exp_f32 v172, v172
    v_sub_f32 v174, v174, v212
    v_exp_f32 v174, v174
    s_nop 0
    v_mul_f32 v213, v168, v169
    v_fmac_f32 v213, v170, v171
    v_fmac_f32 v213, v172, v173
    v_fmac_f32 v213, v174, v175
    v_rcp_f32 v213, v213
    s_nop 0
    v_mul_f32 v168, v168, v213
    v_mul_f32 v170, v170, v213
    v_mul_f32 v172, v172, v213
    v_mul_f32 v174, v174, v213
    v_max_f32 v212, v176, v178
    v_max3_f32 v212, v212, v180, v182
    v_sub_f32 v176, v176, v212
    v_exp_f32 v176, v176
    v_sub_f32 v178, v178, v212
    v_exp_f32 v178, v178
    v_sub_f32 v180, v180, v212
    v_exp_f32 v180, v180
    v_sub_f32 v182, v182, v212
    v_exp_f32 v182, v182
    s_nop 0
    v_mul_f32 v213, v176, v177
    v_fmac_f32 v213, v178, v179
    v_fmac_f32 v213, v180, v181
    v_fmac_f32 v213, v182, v183
    v_rcp_f32 v213, v213
    s_nop 0
    v_mul_f32 v176, v176, v213
    v_mul_f32 v178, v178, v213
    v_mul_f32 v180, v180, v213
    v_mul_f32 v182, v182, v213
    v_mul_f32 v16, v16, v160
    v_mul_f32 v17, v17, v160
    v_mul_f32 v18, v18, v160
    v_mul_f32 v19, v19, v160
    v_mul_f32 v20, v20, v160
    v_mul_f32 v21, v21, v160
    v_mul_f32 v22, v22, v160
    v_mul_f32 v23, v23, v160
    v_mul_f32 v24, v24, v160
    v_mul_f32 v25, v25, v160
    v_mul_f32 v26, v26, v160
    v_mul_f32 v27, v27, v160
    v_mul_f32 v28, v28, v160
    v_mul_f32 v29, v29, v160
    v_mul_f32 v30, v30, v160
    v_mul_f32 v31, v31, v160
    v_mul_f32 v32, v32, v168
    v_mul_f32 v33, v33, v168
    v_mul_f32 v34, v34, v168
    v_mul_f32 v35, v35, v168
    v_mul_f32 v36, v36, v168
    v_mul_f32 v37, v37, v168
    v_mul_f32 v38, v38, v168
    v_mul_f32 v39, v39, v168
    v_mul_f32 v40, v40, v168
    v_mul_f32 v41, v41, v168
    v_mul_f32 v42, v42, v168
    v_mul_f32 v43, v43, v168
    v_mul_f32 v44, v44, v168
    v_mul_f32 v45, v45, v168
    v_mul_f32 v46, v46, v168
    v_mul_f32 v47, v47, v168
    v_mul_f32 v48, v48, v176
    v_mul_f32 v49, v49, v176
    v_mul_f32 v50, v50, v176
    v_mul_f32 v51, v51, v176
    v_mul_f32 v52, v52, v176
    v_mul_f32 v53, v53, v176
    v_mul_f32 v54, v54, v176
    v_mul_f32 v55, v55, v176
    v_mul_f32 v56, v56, v176
    v_mul_f32 v57, v57, v176
    v_mul_f32 v58, v58, v176
    v_mul_f32 v59, v59, v176
    v_mul_f32 v60, v60, v176
    v_mul_f32 v61, v61, v176
    v_mul_f32 v62, v62, v176
    v_mul_f32 v63, v63, v176
    ds_read_b128 v[112:115], v10 offset:1024
    ds_read_b128 v[116:119], v10 offset:2048
    ds_read_b128 v[120:123], v10 offset:3072
    ds_read_b128 v[124:127], v10 offset:4096
    ds_read_b128 v[128:131], v10 offset:5120
    ds_read_b128 v[132:135], v10 offset:6144
    ds_read_b128 v[136:139], v10 offset:7168
    ds_read_b128 v[140:143], v10 offset:8192
    ds_read_b128 v[144:147], v10 offset:9216
    ds_read_b128 v[148:151], v10 offset:10240
    ds_read_b128 v[152:155], v10 offset:11264
    ds_read_b128 v[156:159], v10 offset:12288
    s_waitcnt lgkmcnt(12)
    v_fmac_f32 v16, v64, v162
    v_fmac_f32 v17, v65, v162
    v_fmac_f32 v18, v66, v162
    v_fmac_f32 v19, v67, v162
    v_fmac_f32 v20, v68, v162
    v_fmac_f32 v21, v69, v162
    v_fmac_f32 v22, v70, v162
    v_fmac_f32 v23, v71, v162
    v_fmac_f32 v24, v72, v162
    v_fmac_f32 v25, v73, v162
    v_fmac_f32 v26, v74, v162
    v_fmac_f32 v27, v75, v162
    v_fmac_f32 v28, v76, v162
    v_fmac_f32 v29, v77, v162
    v_fmac_f32 v30, v78, v162
    v_fmac_f32 v31, v79, v162
    v_fmac_f32 v32, v80, v170
    v_fmac_f32 v33, v81, v170
    v_fmac_f32 v34, v82, v170
    v_fmac_f32 v35, v83, v170
    v_fmac_f32 v36, v84, v170
    v_fmac_f32 v37, v85, v170
    v_fmac_f32 v38, v86, v170
    v_fmac_f32 v39, v87, v170
    v_fmac_f32 v40, v88, v170
    v_fmac_f32 v41, v89, v170
    v_fmac_f32 v42, v90, v170
    v_fmac_f32 v43, v91, v170
    v_fmac_f32 v44, v92, v170
    v_fmac_f32 v45, v93, v170
    v_fmac_f32 v46, v94, v170
    v_fmac_f32 v47, v95, v170
    v_fmac_f32 v48, v96, v178
    v_fmac_f32 v49, v97, v178
    v_fmac_f32 v50, v98, v178
    v_fmac_f32 v51, v99, v178
    v_fmac_f32 v52, v100, v178
    v_fmac_f32 v53, v101, v178
    v_fmac_f32 v54, v102, v178
    v_fmac_f32 v55, v103, v178
    v_fmac_f32 v56, v104, v178
    v_fmac_f32 v57, v105, v178
    v_fmac_f32 v58, v106, v178
    v_fmac_f32 v59, v107, v178
    v_fmac_f32 v60, v108, v178
    v_fmac_f32 v61, v109, v178
    v_fmac_f32 v62, v110, v178
    v_fmac_f32 v63, v111, v178
    ds_read_b128 v[64:67], v11 offset:1024
    ds_read_b128 v[68:71], v11 offset:2048
    ds_read_b128 v[72:75], v11 offset:3072
    ds_read_b128 v[76:79], v11 offset:4096
    ds_read_b128 v[80:83], v11 offset:5120
    ds_read_b128 v[84:87], v11 offset:6144
    ds_read_b128 v[88:91], v11 offset:7168
    ds_read_b128 v[92:95], v11 offset:8192
    ds_read_b128 v[96:99], v11 offset:9216
    ds_read_b128 v[100:103], v11 offset:10240
    ds_read_b128 v[104:107], v11 offset:11264
    ds_read_b128 v[108:111], v11 offset:12288
    s_waitcnt lgkmcnt(12)
    v_fmac_f32 v16, v112, v164
    v_fmac_f32 v17, v113, v164
    v_fmac_f32 v18, v114, v164
    v_fmac_f32 v19, v115, v164
    v_fmac_f32 v20, v116, v164
    v_fmac_f32 v21, v117, v164
    v_fmac_f32 v22, v118, v164
    v_fmac_f32 v23, v119, v164
    v_fmac_f32 v24, v120, v164
    v_fmac_f32 v25, v121, v164
    v_fmac_f32 v26, v122, v164
    v_fmac_f32 v27, v123, v164
    v_fmac_f32 v28, v124, v164
    v_fmac_f32 v29, v125, v164
    v_fmac_f32 v30, v126, v164
    v_fmac_f32 v31, v127, v164
    v_fmac_f32 v32, v128, v172
    v_fmac_f32 v33, v129, v172
    v_fmac_f32 v34, v130, v172
    v_fmac_f32 v35, v131, v172
    v_fmac_f32 v36, v132, v172
    v_fmac_f32 v37, v133, v172
    v_fmac_f32 v38, v134, v172
    v_fmac_f32 v39, v135, v172
    v_fmac_f32 v40, v136, v172
    v_fmac_f32 v41, v137, v172
    v_fmac_f32 v42, v138, v172
    v_fmac_f32 v43, v139, v172
    v_fmac_f32 v44, v140, v172
    v_fmac_f32 v45, v141, v172
    v_fmac_f32 v46, v142, v172
    v_fmac_f32 v47, v143, v172
    v_fmac_f32 v48, v144, v180
    v_fmac_f32 v49, v145, v180
    v_fmac_f32 v50, v146, v180
    v_fmac_f32 v51, v147, v180
    v_fmac_f32 v52, v148, v180
    v_fmac_f32 v53, v149, v180
    v_fmac_f32 v54, v150, v180
    v_fmac_f32 v55, v151, v180
    v_fmac_f32 v56, v152, v180
    v_fmac_f32 v57, v153, v180
    v_fmac_f32 v58, v154, v180
    v_fmac_f32 v59, v155, v180
    v_fmac_f32 v60, v156, v180
    v_fmac_f32 v61, v157, v180
    v_fmac_f32 v62, v158, v180
    v_fmac_f32 v63, v159, v180
    s_waitcnt lgkmcnt(0)
    v_fmac_f32 v16, v64, v166
    v_fmac_f32 v17, v65, v166
    v_fmac_f32 v18, v66, v166
    v_fmac_f32 v19, v67, v166
    v_fmac_f32 v20, v68, v166
    v_fmac_f32 v21, v69, v166
    v_fmac_f32 v22, v70, v166
    v_fmac_f32 v23, v71, v166
    v_fmac_f32 v24, v72, v166
    v_fmac_f32 v25, v73, v166
    v_fmac_f32 v26, v74, v166
    v_fmac_f32 v27, v75, v166
    v_fmac_f32 v28, v76, v166
    v_fmac_f32 v29, v77, v166
    v_fmac_f32 v30, v78, v166
    v_fmac_f32 v31, v79, v166
    v_fmac_f32 v32, v80, v174
    v_fmac_f32 v33, v81, v174
    v_fmac_f32 v34, v82, v174
    v_fmac_f32 v35, v83, v174
    v_fmac_f32 v36, v84, v174
    v_fmac_f32 v37, v85, v174
    v_fmac_f32 v38, v86, v174
    v_fmac_f32 v39, v87, v174
    v_fmac_f32 v40, v88, v174
    v_fmac_f32 v41, v89, v174
    v_fmac_f32 v42, v90, v174
    v_fmac_f32 v43, v91, v174
    v_fmac_f32 v44, v92, v174
    v_fmac_f32 v45, v93, v174
    v_fmac_f32 v46, v94, v174
    v_fmac_f32 v47, v95, v174
    v_fmac_f32 v48, v96, v182
    v_fmac_f32 v49, v97, v182
    v_fmac_f32 v50, v98, v182
    v_fmac_f32 v51, v99, v182
    v_fmac_f32 v52, v100, v182
    v_fmac_f32 v53, v101, v182
    v_fmac_f32 v54, v102, v182
    v_fmac_f32 v55, v103, v182
    v_fmac_f32 v56, v104, v182
    v_fmac_f32 v57, v105, v182
    v_fmac_f32 v58, v106, v182
    v_fmac_f32 v59, v107, v182
    v_fmac_f32 v60, v108, v182
    v_fmac_f32 v61, v109, v182
    v_fmac_f32 v62, v110, v182
    v_fmac_f32 v63, v111, v182
    v_cvt_pk_bf16_f32 v112, v16, v17
    v_cvt_pk_bf16_f32 v113, v18, v19
    v_cvt_pk_bf16_f32 v114, v20, v21
    v_cvt_pk_bf16_f32 v115, v22, v23
    s_nop 1
    v_permlane32_swap_b32 v112, v114
    v_permlane32_swap_b32 v113, v115
    buffer_store_dwordx4 v[112:115], v241, s[24:27], 0 offen offset:0
    v_cvt_pk_bf16_f32 v116, v24, v25
    v_cvt_pk_bf16_f32 v117, v26, v27
    v_cvt_pk_bf16_f32 v118, v28, v29
    v_cvt_pk_bf16_f32 v119, v30, v31
    s_nop 1
    v_permlane32_swap_b32 v116, v118
    v_permlane32_swap_b32 v117, v119
    buffer_store_dwordx4 v[116:119], v241, s[24:27], 0 offen offset:32
    v_add_u32 v8, 8192, v241
    v_cvt_pk_bf16_f32 v120, v32, v33
    v_cvt_pk_bf16_f32 v121, v34, v35
    v_cvt_pk_bf16_f32 v122, v36, v37
    v_cvt_pk_bf16_f32 v123, v38, v39
    s_nop 1
    v_permlane32_swap_b32 v120, v122
    v_permlane32_swap_b32 v121, v123
    buffer_store_dwordx4 v[120:123], v8, s[24:27], 0 offen offset:0
    v_cvt_pk_bf16_f32 v124, v40, v41
    v_cvt_pk_bf16_f32 v125, v42, v43
    v_cvt_pk_bf16_f32 v126, v44, v45
    v_cvt_pk_bf16_f32 v127, v46, v47
    s_nop 1
    v_permlane32_swap_b32 v124, v126
    v_permlane32_swap_b32 v125, v127
    buffer_store_dwordx4 v[124:127], v8, s[24:27], 0 offen offset:32
    v_add_u32 v8, 16384, v241
    v_cvt_pk_bf16_f32 v128, v48, v49
    v_cvt_pk_bf16_f32 v129, v50, v51
    v_cvt_pk_bf16_f32 v130, v52, v53
    v_cvt_pk_bf16_f32 v131, v54, v55
    s_nop 1
    v_permlane32_swap_b32 v128, v130
    v_permlane32_swap_b32 v129, v131
    buffer_store_dwordx4 v[128:131], v8, s[24:27], 0 offen offset:0
    v_cvt_pk_bf16_f32 v132, v56, v57
    v_cvt_pk_bf16_f32 v133, v58, v59
    v_cvt_pk_bf16_f32 v134, v60, v61
    v_cvt_pk_bf16_f32 v135, v62, v63
    s_nop 1
    v_permlane32_swap_b32 v132, v134
    v_permlane32_swap_b32 v133, v135
    buffer_store_dwordx4 v[132:135], v8, s[24:27], 0 offen offset:32
    s_endpgm
EPI_1:
    ds_write_b128 v7, a[0:3] offset:1024
    ds_write_b128 v7, a[4:7] offset:2048
    ds_write_b128 v7, a[8:11] offset:3072
    ds_write_b128 v7, a[12:15] offset:4096
    ds_write_b128 v7, a[32:35] offset:13312
    ds_write_b128 v7, a[36:39] offset:14336
    ds_write_b128 v7, a[40:43] offset:15360
    ds_write_b128 v7, a[44:47] offset:16384
    ds_write_b128 v7, a[48:51] offset:25600
    ds_write_b128 v7, a[52:55] offset:26624
    ds_write_b128 v7, a[56:59] offset:27648
    ds_write_b128 v7, a[60:63] offset:28672
    v_accvgpr_read_b32 v16, a16
    v_accvgpr_read_b32 v17, a17
    v_accvgpr_read_b32 v18, a18
    v_accvgpr_read_b32 v19, a19
    v_accvgpr_read_b32 v20, a20
    v_accvgpr_read_b32 v21, a21
    v_accvgpr_read_b32 v22, a22
    v_accvgpr_read_b32 v23, a23
    v_accvgpr_read_b32 v24, a24
    v_accvgpr_read_b32 v25, a25
    v_accvgpr_read_b32 v26, a26
    v_accvgpr_read_b32 v27, a27
    v_accvgpr_read_b32 v28, a28
    v_accvgpr_read_b32 v29, a29
    v_accvgpr_read_b32 v30, a30
    v_accvgpr_read_b32 v31, a31
    ds_write_b128 v7, a[64:67] offset:5120
    ds_write_b128 v7, a[68:71] offset:6144
    ds_write_b128 v7, a[72:75] offset:7168
    ds_write_b128 v7, a[76:79] offset:8192
    ds_write_b128 v7, a[96:99] offset:17408
    ds_write_b128 v7, a[100:103] offset:18432
    ds_write_b128 v7, a[104:107] offset:19456
    ds_write_b128 v7, a[108:111] offset:20480
    ds_write_b128 v7, a[112:115] offset:29696
    ds_write_b128 v7, a[116:119] offset:30720
    ds_write_b128 v7, a[120:123] offset:31744
    ds_write_b128 v7, a[124:127] offset:32768
    v_accvgpr_read_b32 v32, a80
    v_accvgpr_read_b32 v33, a81
    v_accvgpr_read_b32 v34, a82
    v_accvgpr_read_b32 v35, a83
    v_accvgpr_read_b32 v36, a84
    v_accvgpr_read_b32 v37, a85
    v_accvgpr_read_b32 v38, a86
    v_accvgpr_read_b32 v39, a87
    v_accvgpr_read_b32 v40, a88
    v_accvgpr_read_b32 v41, a89
    v_accvgpr_read_b32 v42, a90
    v_accvgpr_read_b32 v43, a91
    v_accvgpr_read_b32 v44, a92
    v_accvgpr_read_b32 v45, a93
    v_accvgpr_read_b32 v46, a94
    v_accvgpr_read_b32 v47, a95
    s_nop 7
    ds_write_b128 v7, a[128:131] offset:9216
    ds_write_b128 v7, a[132:135] offset:10240
    ds_write_b128 v7, a[136:139] offset:11264
    ds_write_b128 v7, a[140:143] offset:12288
    ds_write_b128 v7, a[160:163] offset:21504
    ds_write_b128 v7, a[164:167] offset:22528
    ds_write_b128 v7, a[168:171] offset:23552
    ds_write_b128 v7, a[172:175] offset:24576
    ds_write_b128 v7, a[176:179] offset:33792
    ds_write_b128 v7, a[180:183] offset:34816
    ds_write_b128 v7, a[184:187] offset:35840
    ds_write_b128 v7, a[188:191] offset:36864
    v_accvgpr_read_b32 v48, a144
    v_accvgpr_read_b32 v49, a145
    v_accvgpr_read_b32 v50, a146
    v_accvgpr_read_b32 v51, a147
    v_accvgpr_read_b32 v52, a148
    v_accvgpr_read_b32 v53, a149
    v_accvgpr_read_b32 v54, a150
    v_accvgpr_read_b32 v55, a151
    v_accvgpr_read_b32 v56, a152
    v_accvgpr_read_b32 v57, a153
    v_accvgpr_read_b32 v58, a154
    v_accvgpr_read_b32 v59, a155
    v_accvgpr_read_b32 v60, a156
    v_accvgpr_read_b32 v61, a157
    v_accvgpr_read_b32 v62, a158
    v_accvgpr_read_b32 v63, a159
    s_waitcnt lgkmcnt(0)
    s_barrier
    ds_read_b64 v[160:161], v4 offset:0
    ds_read_b64 v[162:163], v4 offset:40960
    v_add_u32 v8, 81920, v4
    ds_read_b64 v[164:165], v8 offset:0
    v_add_u32 v8, 122880, v4
    ds_read_b64 v[166:167], v8 offset:0
    ds_read_b64 v[168:169], v4 offset:256
    ds_read_b64 v[170:171], v4 offset:41216
    v_add_u32 v8, 81920, v4
    ds_read_b64 v[172:173], v8 offset:256
    v_add_u32 v8, 122880, v4
    ds_read_b64 v[174:175], v8 offset:256
    ds_read_b64 v[176:177], v4 offset:512
    ds_read_b64 v[178:179], v4 offset:41472
    v_add_u32 v8, 81920, v4
    ds_read_b64 v[180:181], v8 offset:512
    v_add_u32 v8, 122880, v4
    ds_read_b64 v[182:183], v8 offset:512
    v_add_u32 v9, 0, v6
    v_add_u32 v10, 81920, v6
    v_add_u32 v11, 122880, v6
    ds_read_b128 v[64:67], v9 offset:1024
    ds_read_b128 v[68:71], v9 offset:2048
    ds_read_b128 v[72:75], v9 offset:3072
    ds_read_b128 v[76:79], v9 offset:4096
    ds_read_b128 v[80:83], v9 offset:5120
    ds_read_b128 v[84:87], v9 offset:6144
    ds_read_b128 v[88:91], v9 offset:7168
    ds_read_b128 v[92:95], v9 offset:8192
    ds_read_b128 v[96:99], v9 offset:9216
    ds_read_b128 v[100:103], v9 offset:10240
    ds_read_b128 v[104:107], v9 offset:11264
    ds_read_b128 v[108:111], v9 offset:12288
    s_waitcnt lgkmcnt(12)
    v_max_f32 v212, v160, v162
    v_max3_f32 v212, v212, v164, v166
    v_sub_f32 v160, v160, v212
    v_exp_f32 v160, v160
    v_sub_f32 v162, v162, v212
    v_exp_f32 v162, v162
    v_sub_f32 v164, v164, v212
    v_exp_f32 v164, v164
    v_sub_f32 v166, v166, v212
    v_exp_f32 v166, v166
    s_nop 0
    v_mul_f32 v213, v160, v161
    v_fmac_f32 v213, v162, v163
    v_fmac_f32 v213, v164, v165
    v_fmac_f32 v213, v166, v167
    v_rcp_f32 v213, v213
    s_nop 0
    v_mul_f32 v160, v160, v213
    v_mul_f32 v162, v162, v213
    v_mul_f32 v164, v164, v213
    v_mul_f32 v166, v166, v213
    v_max_f32 v212, v168, v170
    v_max3_f32 v212, v212, v172, v174
    v_sub_f32 v168, v168, v212
    v_exp_f32 v168, v168
    v_sub_f32 v170, v170, v212
    v_exp_f32 v170, v170
    v_sub_f32 v172, v172, v212
    v_exp_f32 v172, v172
    v_sub_f32 v174, v174, v212
    v_exp_f32 v174, v174
    s_nop 0
    v_mul_f32 v213, v168, v169
    v_fmac_f32 v213, v170, v171
    v_fmac_f32 v213, v172, v173
    v_fmac_f32 v213, v174, v175
    v_rcp_f32 v213, v213
    s_nop 0
    v_mul_f32 v168, v168, v213
    v_mul_f32 v170, v170, v213
    v_mul_f32 v172, v172, v213
    v_mul_f32 v174, v174, v213
    v_max_f32 v212, v176, v178
    v_max3_f32 v212, v212, v180, v182
    v_sub_f32 v176, v176, v212
    v_exp_f32 v176, v176
    v_sub_f32 v178, v178, v212
    v_exp_f32 v178, v178
    v_sub_f32 v180, v180, v212
    v_exp_f32 v180, v180
    v_sub_f32 v182, v182, v212
    v_exp_f32 v182, v182
    s_nop 0
    v_mul_f32 v213, v176, v177
    v_fmac_f32 v213, v178, v179
    v_fmac_f32 v213, v180, v181
    v_fmac_f32 v213, v182, v183
    v_rcp_f32 v213, v213
    s_nop 0
    v_mul_f32 v176, v176, v213
    v_mul_f32 v178, v178, v213
    v_mul_f32 v180, v180, v213
    v_mul_f32 v182, v182, v213
    v_mul_f32 v16, v16, v162
    v_mul_f32 v17, v17, v162
    v_mul_f32 v18, v18, v162
    v_mul_f32 v19, v19, v162
    v_mul_f32 v20, v20, v162
    v_mul_f32 v21, v21, v162
    v_mul_f32 v22, v22, v162
    v_mul_f32 v23, v23, v162
    v_mul_f32 v24, v24, v162
    v_mul_f32 v25, v25, v162
    v_mul_f32 v26, v26, v162
    v_mul_f32 v27, v27, v162
    v_mul_f32 v28, v28, v162
    v_mul_f32 v29, v29, v162
    v_mul_f32 v30, v30, v162
    v_mul_f32 v31, v31, v162
    v_mul_f32 v32, v32, v170
    v_mul_f32 v33, v33, v170
    v_mul_f32 v34, v34, v170
    v_mul_f32 v35, v35, v170
    v_mul_f32 v36, v36, v170
    v_mul_f32 v37, v37, v170
    v_mul_f32 v38, v38, v170
    v_mul_f32 v39, v39, v170
    v_mul_f32 v40, v40, v170
    v_mul_f32 v41, v41, v170
    v_mul_f32 v42, v42, v170
    v_mul_f32 v43, v43, v170
    v_mul_f32 v44, v44, v170
    v_mul_f32 v45, v45, v170
    v_mul_f32 v46, v46, v170
    v_mul_f32 v47, v47, v170
    v_mul_f32 v48, v48, v178
    v_mul_f32 v49, v49, v178
    v_mul_f32 v50, v50, v178
    v_mul_f32 v51, v51, v178
    v_mul_f32 v52, v52, v178
    v_mul_f32 v53, v53, v178
    v_mul_f32 v54, v54, v178
    v_mul_f32 v55, v55, v178
    v_mul_f32 v56, v56, v178
    v_mul_f32 v57, v57, v178
    v_mul_f32 v58, v58, v178
    v_mul_f32 v59, v59, v178
    v_mul_f32 v60, v60, v178
    v_mul_f32 v61, v61, v178
    v_mul_f32 v62, v62, v178
    v_mul_f32 v63, v63, v178
    ds_read_b128 v[112:115], v10 offset:13312
    ds_read_b128 v[116:119], v10 offset:14336
    ds_read_b128 v[120:123], v10 offset:15360
    ds_read_b128 v[124:127], v10 offset:16384
    ds_read_b128 v[128:131], v10 offset:17408
    ds_read_b128 v[132:135], v10 offset:18432
    ds_read_b128 v[136:139], v10 offset:19456
    ds_read_b128 v[140:143], v10 offset:20480
    ds_read_b128 v[144:147], v10 offset:21504
    ds_read_b128 v[148:151], v10 offset:22528
    ds_read_b128 v[152:155], v10 offset:23552
    ds_read_b128 v[156:159], v10 offset:24576
    s_waitcnt lgkmcnt(12)
    v_fmac_f32 v16, v64, v160
    v_fmac_f32 v17, v65, v160
    v_fmac_f32 v18, v66, v160
    v_fmac_f32 v19, v67, v160
    v_fmac_f32 v20, v68, v160
    v_fmac_f32 v21, v69, v160
    v_fmac_f32 v22, v70, v160
    v_fmac_f32 v23, v71, v160
    v_fmac_f32 v24, v72, v160
    v_fmac_f32 v25, v73, v160
    v_fmac_f32 v26, v74, v160
    v_fmac_f32 v27, v75, v160
    v_fmac_f32 v28, v76, v160
    v_fmac_f32 v29, v77, v160
    v_fmac_f32 v30, v78, v160
    v_fmac_f32 v31, v79, v160
    v_fmac_f32 v32, v80, v168
    v_fmac_f32 v33, v81, v168
    v_fmac_f32 v34, v82, v168
    v_fmac_f32 v35, v83, v168
    v_fmac_f32 v36, v84, v168
    v_fmac_f32 v37, v85, v168
    v_fmac_f32 v38, v86, v168
    v_fmac_f32 v39, v87, v168
    v_fmac_f32 v40, v88, v168
    v_fmac_f32 v41, v89, v168
    v_fmac_f32 v42, v90, v168
    v_fmac_f32 v43, v91, v168
    v_fmac_f32 v44, v92, v168
    v_fmac_f32 v45, v93, v168
    v_fmac_f32 v46, v94, v168
    v_fmac_f32 v47, v95, v168
    v_fmac_f32 v48, v96, v176
    v_fmac_f32 v49, v97, v176
    v_fmac_f32 v50, v98, v176
    v_fmac_f32 v51, v99, v176
    v_fmac_f32 v52, v100, v176
    v_fmac_f32 v53, v101, v176
    v_fmac_f32 v54, v102, v176
    v_fmac_f32 v55, v103, v176
    v_fmac_f32 v56, v104, v176
    v_fmac_f32 v57, v105, v176
    v_fmac_f32 v58, v106, v176
    v_fmac_f32 v59, v107, v176
    v_fmac_f32 v60, v108, v176
    v_fmac_f32 v61, v109, v176
    v_fmac_f32 v62, v110, v176
    v_fmac_f32 v63, v111, v176
    ds_read_b128 v[64:67], v11 offset:13312
    ds_read_b128 v[68:71], v11 offset:14336
    ds_read_b128 v[72:75], v11 offset:15360
    ds_read_b128 v[76:79], v11 offset:16384
    ds_read_b128 v[80:83], v11 offset:17408
    ds_read_b128 v[84:87], v11 offset:18432
    ds_read_b128 v[88:91], v11 offset:19456
    ds_read_b128 v[92:95], v11 offset:20480
    ds_read_b128 v[96:99], v11 offset:21504
    ds_read_b128 v[100:103], v11 offset:22528
    ds_read_b128 v[104:107], v11 offset:23552
    ds_read_b128 v[108:111], v11 offset:24576
    s_waitcnt lgkmcnt(12)
    v_fmac_f32 v16, v112, v164
    v_fmac_f32 v17, v113, v164
    v_fmac_f32 v18, v114, v164
    v_fmac_f32 v19, v115, v164
    v_fmac_f32 v20, v116, v164
    v_fmac_f32 v21, v117, v164
    v_fmac_f32 v22, v118, v164
    v_fmac_f32 v23, v119, v164
    v_fmac_f32 v24, v120, v164
    v_fmac_f32 v25, v121, v164
    v_fmac_f32 v26, v122, v164
    v_fmac_f32 v27, v123, v164
    v_fmac_f32 v28, v124, v164
    v_fmac_f32 v29, v125, v164
    v_fmac_f32 v30, v126, v164
    v_fmac_f32 v31, v127, v164
    v_fmac_f32 v32, v128, v172
    v_fmac_f32 v33, v129, v172
    v_fmac_f32 v34, v130, v172
    v_fmac_f32 v35, v131, v172
    v_fmac_f32 v36, v132, v172
    v_fmac_f32 v37, v133, v172
    v_fmac_f32 v38, v134, v172
    v_fmac_f32 v39, v135, v172
    v_fmac_f32 v40, v136, v172
    v_fmac_f32 v41, v137, v172
    v_fmac_f32 v42, v138, v172
    v_fmac_f32 v43, v139, v172
    v_fmac_f32 v44, v140, v172
    v_fmac_f32 v45, v141, v172
    v_fmac_f32 v46, v142, v172
    v_fmac_f32 v47, v143, v172
    v_fmac_f32 v48, v144, v180
    v_fmac_f32 v49, v145, v180
    v_fmac_f32 v50, v146, v180
    v_fmac_f32 v51, v147, v180
    v_fmac_f32 v52, v148, v180
    v_fmac_f32 v53, v149, v180
    v_fmac_f32 v54, v150, v180
    v_fmac_f32 v55, v151, v180
    v_fmac_f32 v56, v152, v180
    v_fmac_f32 v57, v153, v180
    v_fmac_f32 v58, v154, v180
    v_fmac_f32 v59, v155, v180
    v_fmac_f32 v60, v156, v180
    v_fmac_f32 v61, v157, v180
    v_fmac_f32 v62, v158, v180
    v_fmac_f32 v63, v159, v180
    s_waitcnt lgkmcnt(0)
    v_fmac_f32 v16, v64, v166
    v_fmac_f32 v17, v65, v166
    v_fmac_f32 v18, v66, v166
    v_fmac_f32 v19, v67, v166
    v_fmac_f32 v20, v68, v166
    v_fmac_f32 v21, v69, v166
    v_fmac_f32 v22, v70, v166
    v_fmac_f32 v23, v71, v166
    v_fmac_f32 v24, v72, v166
    v_fmac_f32 v25, v73, v166
    v_fmac_f32 v26, v74, v166
    v_fmac_f32 v27, v75, v166
    v_fmac_f32 v28, v76, v166
    v_fmac_f32 v29, v77, v166
    v_fmac_f32 v30, v78, v166
    v_fmac_f32 v31, v79, v166
    v_fmac_f32 v32, v80, v174
    v_fmac_f32 v33, v81, v174
    v_fmac_f32 v34, v82, v174
    v_fmac_f32 v35, v83, v174
    v_fmac_f32 v36, v84, v174
    v_fmac_f32 v37, v85, v174
    v_fmac_f32 v38, v86, v174
    v_fmac_f32 v39, v87, v174
    v_fmac_f32 v40, v88, v174
    v_fmac_f32 v41, v89, v174
    v_fmac_f32 v42, v90, v174
    v_fmac_f32 v43, v91, v174
    v_fmac_f32 v44, v92, v174
    v_fmac_f32 v45, v93, v174
    v_fmac_f32 v46, v94, v174
    v_fmac_f32 v47, v95, v174
    v_fmac_f32 v48, v96, v182
    v_fmac_f32 v49, v97, v182
    v_fmac_f32 v50, v98, v182
    v_fmac_f32 v51, v99, v182
    v_fmac_f32 v52, v100, v182
    v_fmac_f32 v53, v101, v182
    v_fmac_f32 v54, v102, v182
    v_fmac_f32 v55, v103, v182
    v_fmac_f32 v56, v104, v182
    v_fmac_f32 v57, v105, v182
    v_fmac_f32 v58, v106, v182
    v_fmac_f32 v59, v107, v182
    v_fmac_f32 v60, v108, v182
    v_fmac_f32 v61, v109, v182
    v_fmac_f32 v62, v110, v182
    v_fmac_f32 v63, v111, v182
    v_cvt_pk_bf16_f32 v112, v16, v17
    v_cvt_pk_bf16_f32 v113, v18, v19
    v_cvt_pk_bf16_f32 v114, v20, v21
    v_cvt_pk_bf16_f32 v115, v22, v23
    s_nop 1
    v_permlane32_swap_b32 v112, v114
    v_permlane32_swap_b32 v113, v115
    buffer_store_dwordx4 v[112:115], v241, s[24:27], 0 offen offset:0
    v_cvt_pk_bf16_f32 v116, v24, v25
    v_cvt_pk_bf16_f32 v117, v26, v27
    v_cvt_pk_bf16_f32 v118, v28, v29
    v_cvt_pk_bf16_f32 v119, v30, v31
    s_nop 1
    v_permlane32_swap_b32 v116, v118
    v_permlane32_swap_b32 v117, v119
    buffer_store_dwordx4 v[116:119], v241, s[24:27], 0 offen offset:32
    v_add_u32 v8, 8192, v241
    v_cvt_pk_bf16_f32 v120, v32, v33
    v_cvt_pk_bf16_f32 v121, v34, v35
    v_cvt_pk_bf16_f32 v122, v36, v37
    v_cvt_pk_bf16_f32 v123, v38, v39
    s_nop 1
    v_permlane32_swap_b32 v120, v122
    v_permlane32_swap_b32 v121, v123
    buffer_store_dwordx4 v[120:123], v8, s[24:27], 0 offen offset:0
    v_cvt_pk_bf16_f32 v124, v40, v41
    v_cvt_pk_bf16_f32 v125, v42, v43
    v_cvt_pk_bf16_f32 v126, v44, v45
    v_cvt_pk_bf16_f32 v127, v46, v47
    s_nop 1
    v_permlane32_swap_b32 v124, v126
    v_permlane32_swap_b32 v125, v127
    buffer_store_dwordx4 v[124:127], v8, s[24:27], 0 offen offset:32
    v_add_u32 v8, 16384, v241
    v_cvt_pk_bf16_f32 v128, v48, v49
    v_cvt_pk_bf16_f32 v129, v50, v51
    v_cvt_pk_bf16_f32 v130, v52, v53
    v_cvt_pk_bf16_f32 v131, v54, v55
    s_nop 1
    v_permlane32_swap_b32 v128, v130
    v_permlane32_swap_b32 v129, v131
    buffer_store_dwordx4 v[128:131], v8, s[24:27], 0 offen offset:0
    v_cvt_pk_bf16_f32 v132, v56, v57
    v_cvt_pk_bf16_f32 v133, v58, v59
    v_cvt_pk_bf16_f32 v134, v60, v61
    v_cvt_pk_bf16_f32 v135, v62, v63
    s_nop 1
    v_permlane32_swap_b32 v132, v134
    v_permlane32_swap_b32 v133, v135
    buffer_store_dwordx4 v[132:135], v8, s[24:27], 0 offen offset:32
    s_endpgm
EPI_2:
    ds_write_b128 v7, a[0:3] offset:1024
    ds_write_b128 v7, a[4:7] offset:2048
    ds_write_b128 v7, a[8:11] offset:3072
    ds_write_b128 v7, a[12:15] offset:4096
    ds_write_b128 v7, a[16:19] offset:13312
    ds_write_b128 v7, a[20:23] offset:14336
    ds_write_b128 v7, a[24:27] offset:15360
    ds_write_b128 v7, a[28:31] offset:16384
    ds_write_b128 v7, a[48:51] offset:25600
    ds_write_b128 v7, a[52:55] offset:26624
    ds_write_b128 v7, a[56:59] offset:27648
    ds_write_b128 v7, a[60:63] offset:28672
    v_accvgpr_read_b32 v16, a32
    v_accvgpr_read_b32 v17, a33
    v_accvgpr_read_b32 v18, a34
    v_accvgpr_read_b32 v19, a35
    v_accvgpr_read_b32 v20, a36
    v_accvgpr_read_b32 v21, a37
    v_accvgpr_read_b32 v22, a38
    v_accvgpr_read_b32 v23, a39
    v_accvgpr_read_b32 v24, a40
    v_accvgpr_read_b32 v25, a41
    v_accvgpr_read_b32 v26, a42
    v_accvgpr_read_b32 v27, a43
    v_accvgpr_read_b32 v28, a44
    v_accvgpr_read_b32 v29, a45
    v_accvgpr_read_b32 v30, a46
    v_accvgpr_read_b32 v31, a47
    ds_write_b128 v7, a[64:67] offset:5120
    ds_write_b128 v7, a[68:71] offset:6144
    ds_write_b128 v7, a[72:75] offset:7168
    ds_write_b128 v7, a[76:79] offset:8192
    ds_write_b128 v7, a[80:83] offset:17408
    ds_write_b128 v7, a[84:87] offset:18432
    ds_write_b128 v7, a[88:91] offset:19456
    ds_write_b128 v7, a[92:95] offset:20480
    ds_write_b128 v7, a[112:115] offset:29696
    ds_write_b128 v7, a[116:119] offset:30720
    ds_write_b128 v7, a[120:123] offset:31744
    ds_write_b128 v7, a[124:127] offset:32768
    v_accvgpr_read_b32 v32, a96
    v_accvgpr_read_b32 v33, a97
    v_accvgpr_read_b32 v34, a98
    v_accvgpr_read_b32 v35, a99
    v_accvgpr_read_b32 v36, a100
    v_accvgpr_read_b32 v37, a101
    v_accvgpr_read_b32 v38, a102
    v_accvgpr_read_b32 v39, a103
    v_accvgpr_read_b32 v40, a104
    v_accvgpr_read_b32 v41, a105
    v_accvgpr_read_b32 v42, a106
    v_accvgpr_read_b32 v43, a107
    v_accvgpr_read_b32 v44, a108
    v_accvgpr_read_b32 v45, a109
    v_accvgpr_read_b32 v46, a110
    v_accvgpr_read_b32 v47, a111
    s_nop 7
    ds_write_b128 v7, a[128:131] offset:9216
    ds_write_b128 v7, a[132:135] offset:10240
    ds_write_b128 v7, a[136:139] offset:11264
    ds_write_b128 v7, a[140:143] offset:12288
    ds_write_b128 v7, a[144:147] offset:21504
    ds_write_b128 v7, a[148:151] offset:22528
    ds_write_b128 v7, a[152:155] offset:23552
    ds_write_b128 v7, a[156:159] offset:24576
    ds_write_b128 v7, a[176:179] offset:33792
    ds_write_b128 v7, a[180:183] offset:34816
    ds_write_b128 v7, a[184:187] offset:35840
    ds_write_b128 v7, a[188:191] offset:36864
    v_accvgpr_read_b32 v48, a160
    v_accvgpr_read_b32 v49, a161
    v_accvgpr_read_b32 v50, a162
    v_accvgpr_read_b32 v51, a163
    v_accvgpr_read_b32 v52, a164
    v_accvgpr_read_b32 v53, a165
    v_accvgpr_read_b32 v54, a166
    v_accvgpr_read_b32 v55, a167
    v_accvgpr_read_b32 v56, a168
    v_accvgpr_read_b32 v57, a169
    v_accvgpr_read_b32 v58, a170
    v_accvgpr_read_b32 v59, a171
    v_accvgpr_read_b32 v60, a172
    v_accvgpr_read_b32 v61, a173
    v_accvgpr_read_b32 v62, a174
    v_accvgpr_read_b32 v63, a175
    s_waitcnt lgkmcnt(0)
    s_barrier
    ds_read_b64 v[160:161], v4 offset:0
    ds_read_b64 v[162:163], v4 offset:40960
    v_add_u32 v8, 81920, v4
    ds_read_b64 v[164:165], v8 offset:0
    v_add_u32 v8, 122880, v4
    ds_read_b64 v[166:167], v8 offset:0
    ds_read_b64 v[168:169], v4 offset:256
    ds_read_b64 v[170:171], v4 offset:41216
    v_add_u32 v8, 81920, v4
    ds_read_b64 v[172:173], v8 offset:256
    v_add_u32 v8, 122880, v4
    ds_read_b64 v[174:175], v8 offset:256
    ds_read_b64 v[176:177], v4 offset:512
    ds_read_b64 v[178:179], v4 offset:41472
    v_add_u32 v8, 81920, v4
    ds_read_b64 v[180:181], v8 offset:512
    v_add_u32 v8, 122880, v4
    ds_read_b64 v[182:183], v8 offset:512
    v_add_u32 v9, 0, v6
    v_add_u32 v10, 40960, v6
    v_add_u32 v11, 122880, v6
    ds_read_b128 v[64:67], v9 offset:13312
    ds_read_b128 v[68:71], v9 offset:14336
    ds_read_b128 v[72:75], v9 offset:15360
    ds_read_b128 v[76:79], v9 offset:16384
    ds_read_b128 v[80:83], v9 offset:17408
    ds_read_b128 v[84:87], v9 offset:18432
    ds_read_b128 v[88:91], v9 offset:19456
    ds_read_b128 v[92:95], v9 offset:20480
    ds_read_b128 v[96:99], v9 offset:21504
    ds_read_b128 v[100:103], v9 offset:22528
    ds_read_b128 v[104:107], v9 offset:23552
    ds_read_b128 v[108:111], v9 offset:24576
    s_waitcnt lgkmcnt(12)
    v_max_f32 v212, v160, v162
    v_max3_f32 v212, v212, v164, v166
    v_sub_f32 v160, v160, v212
    v_exp_f32 v160, v160
    v_sub_f32 v162, v162, v212
    v_exp_f32 v162, v162
    v_sub_f32 v164, v164, v212
    v_exp_f32 v164, v164
    v_sub_f32 v166, v166, v212
    v_exp_f32 v166, v166
    s_nop 0
    v_mul_f32 v213, v160, v161
    v_fmac_f32 v213, v162, v163
    v_fmac_f32 v213, v164, v165
    v_fmac_f32 v213, v166, v167
    v_rcp_f32 v213, v213
    s_nop 0
    v_mul_f32 v160, v160, v213
    v_mul_f32 v162, v162, v213
    v_mul_f32 v164, v164, v213
    v_mul_f32 v166, v166, v213
    v_max_f32 v212, v168, v170
    v_max3_f32 v212, v212, v172, v174
    v_sub_f32 v168, v168, v212
    v_exp_f32 v168, v168
    v_sub_f32 v170, v170, v212
    v_exp_f32 v170, v170
    v_sub_f32 v172, v172, v212
    v_exp_f32 v172, v172
    v_sub_f32 v174, v174, v212
    v_exp_f32 v174, v174
    s_nop 0
    v_mul_f32 v213, v168, v169
    v_fmac_f32 v213, v170, v171
    v_fmac_f32 v213, v172, v173
    v_fmac_f32 v213, v174, v175
    v_rcp_f32 v213, v213
    s_nop 0
    v_mul_f32 v168, v168, v213
    v_mul_f32 v170, v170, v213
    v_mul_f32 v172, v172, v213
    v_mul_f32 v174, v174, v213
    v_max_f32 v212, v176, v178
    v_max3_f32 v212, v212, v180, v182
    v_sub_f32 v176, v176, v212
    v_exp_f32 v176, v176
    v_sub_f32 v178, v178, v212
    v_exp_f32 v178, v178
    v_sub_f32 v180, v180, v212
    v_exp_f32 v180, v180
    v_sub_f32 v182, v182, v212
    v_exp_f32 v182, v182
    s_nop 0
    v_mul_f32 v213, v176, v177
    v_fmac_f32 v213, v178, v179
    v_fmac_f32 v213, v180, v181
    v_fmac_f32 v213, v182, v183
    v_rcp_f32 v213, v213
    s_nop 0
    v_mul_f32 v176, v176, v213
    v_mul_f32 v178, v178, v213
    v_mul_f32 v180, v180, v213
    v_mul_f32 v182, v182, v213
    v_mul_f32 v16, v16, v164
    v_mul_f32 v17, v17, v164
    v_mul_f32 v18, v18, v164
    v_mul_f32 v19, v19, v164
    v_mul_f32 v20, v20, v164
    v_mul_f32 v21, v21, v164
    v_mul_f32 v22, v22, v164
    v_mul_f32 v23, v23, v164
    v_mul_f32 v24, v24, v164
    v_mul_f32 v25, v25, v164
    v_mul_f32 v26, v26, v164
    v_mul_f32 v27, v27, v164
    v_mul_f32 v28, v28, v164
    v_mul_f32 v29, v29, v164
    v_mul_f32 v30, v30, v164
    v_mul_f32 v31, v31, v164
    v_mul_f32 v32, v32, v172
    v_mul_f32 v33, v33, v172
    v_mul_f32 v34, v34, v172
    v_mul_f32 v35, v35, v172
    v_mul_f32 v36, v36, v172
    v_mul_f32 v37, v37, v172
    v_mul_f32 v38, v38, v172
    v_mul_f32 v39, v39, v172
    v_mul_f32 v40, v40, v172
    v_mul_f32 v41, v41, v172
    v_mul_f32 v42, v42, v172
    v_mul_f32 v43, v43, v172
    v_mul_f32 v44, v44, v172
    v_mul_f32 v45, v45, v172
    v_mul_f32 v46, v46, v172
    v_mul_f32 v47, v47, v172
    v_mul_f32 v48, v48, v180
    v_mul_f32 v49, v49, v180
    v_mul_f32 v50, v50, v180
    v_mul_f32 v51, v51, v180
    v_mul_f32 v52, v52, v180
    v_mul_f32 v53, v53, v180
    v_mul_f32 v54, v54, v180
    v_mul_f32 v55, v55, v180
    v_mul_f32 v56, v56, v180
    v_mul_f32 v57, v57, v180
    v_mul_f32 v58, v58, v180
    v_mul_f32 v59, v59, v180
    v_mul_f32 v60, v60, v180
    v_mul_f32 v61, v61, v180
    v_mul_f32 v62, v62, v180
    v_mul_f32 v63, v63, v180
    ds_read_b128 v[112:115], v10 offset:13312
    ds_read_b128 v[116:119], v10 offset:14336
    ds_read_b128 v[120:123], v10 offset:15360
    ds_read_b128 v[124:127], v10 offset:16384
    ds_read_b128 v[128:131], v10 offset:17408
    ds_read_b128 v[132:135], v10 offset:18432
    ds_read_b128 v[136:139], v10 offset:19456
    ds_read_b128 v[140:143], v10 offset:20480
    ds_read_b128 v[144:147], v10 offset:21504
    ds_read_b128 v[148:151], v10 offset:22528
    ds_read_b128 v[152:155], v10 offset:23552
    ds_read_b128 v[156:159], v10 offset:24576
    s_waitcnt lgkmcnt(12)
    v_fmac_f32 v16, v64, v160
    v_fmac_f32 v17, v65, v160
    v_fmac_f32 v18, v66, v160
    v_fmac_f32 v19, v67, v160
    v_fmac_f32 v20, v68, v160
    v_fmac_f32 v21, v69, v160
    v_fmac_f32 v22, v70, v160
    v_fmac_f32 v23, v71, v160
    v_fmac_f32 v24, v72, v160
    v_fmac_f32 v25, v73, v160
    v_fmac_f32 v26, v74, v160
    v_fmac_f32 v27, v75, v160
    v_fmac_f32 v28, v76, v160
    v_fmac_f32 v29, v77, v160
    v_fmac_f32 v30, v78, v160
    v_fmac_f32 v31, v79, v160
    v_fmac_f32 v32, v80, v168
    v_fmac_f32 v33, v81, v168
    v_fmac_f32 v34, v82, v168
    v_fmac_f32 v35, v83, v168
    v_fmac_f32 v36, v84, v168
    v_fmac_f32 v37, v85, v168
    v_fmac_f32 v38, v86, v168
    v_fmac_f32 v39, v87, v168
    v_fmac_f32 v40, v88, v168
    v_fmac_f32 v41, v89, v168
    v_fmac_f32 v42, v90, v168
    v_fmac_f32 v43, v91, v168
    v_fmac_f32 v44, v92, v168
    v_fmac_f32 v45, v93, v168
    v_fmac_f32 v46, v94, v168
    v_fmac_f32 v47, v95, v168
    v_fmac_f32 v48, v96, v176
    v_fmac_f32 v49, v97, v176
    v_fmac_f32 v50, v98, v176
    v_fmac_f32 v51, v99, v176
    v_fmac_f32 v52, v100, v176
    v_fmac_f32 v53, v101, v176
    v_fmac_f32 v54, v102, v176
    v_fmac_f32 v55, v103, v176
    v_fmac_f32 v56, v104, v176
    v_fmac_f32 v57, v105, v176
    v_fmac_f32 v58, v106, v176
    v_fmac_f32 v59, v107, v176
    v_fmac_f32 v60, v108, v176
    v_fmac_f32 v61, v109, v176
    v_fmac_f32 v62, v110, v176
    v_fmac_f32 v63, v111, v176
    ds_read_b128 v[64:67], v11 offset:25600
    ds_read_b128 v[68:71], v11 offset:26624
    ds_read_b128 v[72:75], v11 offset:27648
    ds_read_b128 v[76:79], v11 offset:28672
    ds_read_b128 v[80:83], v11 offset:29696
    ds_read_b128 v[84:87], v11 offset:30720
    ds_read_b128 v[88:91], v11 offset:31744
    ds_read_b128 v[92:95], v11 offset:32768
    ds_read_b128 v[96:99], v11 offset:33792
    ds_read_b128 v[100:103], v11 offset:34816
    ds_read_b128 v[104:107], v11 offset:35840
    ds_read_b128 v[108:111], v11 offset:36864
    s_waitcnt lgkmcnt(12)
    v_fmac_f32 v16, v112, v162
    v_fmac_f32 v17, v113, v162
    v_fmac_f32 v18, v114, v162
    v_fmac_f32 v19, v115, v162
    v_fmac_f32 v20, v116, v162
    v_fmac_f32 v21, v117, v162
    v_fmac_f32 v22, v118, v162
    v_fmac_f32 v23, v119, v162
    v_fmac_f32 v24, v120, v162
    v_fmac_f32 v25, v121, v162
    v_fmac_f32 v26, v122, v162
    v_fmac_f32 v27, v123, v162
    v_fmac_f32 v28, v124, v162
    v_fmac_f32 v29, v125, v162
    v_fmac_f32 v30, v126, v162
    v_fmac_f32 v31, v127, v162
    v_fmac_f32 v32, v128, v170
    v_fmac_f32 v33, v129, v170
    v_fmac_f32 v34, v130, v170
    v_fmac_f32 v35, v131, v170
    v_fmac_f32 v36, v132, v170
    v_fmac_f32 v37, v133, v170
    v_fmac_f32 v38, v134, v170
    v_fmac_f32 v39, v135, v170
    v_fmac_f32 v40, v136, v170
    v_fmac_f32 v41, v137, v170
    v_fmac_f32 v42, v138, v170
    v_fmac_f32 v43, v139, v170
    v_fmac_f32 v44, v140, v170
    v_fmac_f32 v45, v141, v170
    v_fmac_f32 v46, v142, v170
    v_fmac_f32 v47, v143, v170
    v_fmac_f32 v48, v144, v178
    v_fmac_f32 v49, v145, v178
    v_fmac_f32 v50, v146, v178
    v_fmac_f32 v51, v147, v178
    v_fmac_f32 v52, v148, v178
    v_fmac_f32 v53, v149, v178
    v_fmac_f32 v54, v150, v178
    v_fmac_f32 v55, v151, v178
    v_fmac_f32 v56, v152, v178
    v_fmac_f32 v57, v153, v178
    v_fmac_f32 v58, v154, v178
    v_fmac_f32 v59, v155, v178
    v_fmac_f32 v60, v156, v178
    v_fmac_f32 v61, v157, v178
    v_fmac_f32 v62, v158, v178
    v_fmac_f32 v63, v159, v178
    s_waitcnt lgkmcnt(0)
    v_fmac_f32 v16, v64, v166
    v_fmac_f32 v17, v65, v166
    v_fmac_f32 v18, v66, v166
    v_fmac_f32 v19, v67, v166
    v_fmac_f32 v20, v68, v166
    v_fmac_f32 v21, v69, v166
    v_fmac_f32 v22, v70, v166
    v_fmac_f32 v23, v71, v166
    v_fmac_f32 v24, v72, v166
    v_fmac_f32 v25, v73, v166
    v_fmac_f32 v26, v74, v166
    v_fmac_f32 v27, v75, v166
    v_fmac_f32 v28, v76, v166
    v_fmac_f32 v29, v77, v166
    v_fmac_f32 v30, v78, v166
    v_fmac_f32 v31, v79, v166
    v_fmac_f32 v32, v80, v174
    v_fmac_f32 v33, v81, v174
    v_fmac_f32 v34, v82, v174
    v_fmac_f32 v35, v83, v174
    v_fmac_f32 v36, v84, v174
    v_fmac_f32 v37, v85, v174
    v_fmac_f32 v38, v86, v174
    v_fmac_f32 v39, v87, v174
    v_fmac_f32 v40, v88, v174
    v_fmac_f32 v41, v89, v174
    v_fmac_f32 v42, v90, v174
    v_fmac_f32 v43, v91, v174
    v_fmac_f32 v44, v92, v174
    v_fmac_f32 v45, v93, v174
    v_fmac_f32 v46, v94, v174
    v_fmac_f32 v47, v95, v174
    v_fmac_f32 v48, v96, v182
    v_fmac_f32 v49, v97, v182
    v_fmac_f32 v50, v98, v182
    v_fmac_f32 v51, v99, v182
    v_fmac_f32 v52, v100, v182
    v_fmac_f32 v53, v101, v182
    v_fmac_f32 v54, v102, v182
    v_fmac_f32 v55, v103, v182
    v_fmac_f32 v56, v104, v182
    v_fmac_f32 v57, v105, v182
    v_fmac_f32 v58, v106, v182
    v_fmac_f32 v59, v107, v182
    v_fmac_f32 v60, v108, v182
    v_fmac_f32 v61, v109, v182
    v_fmac_f32 v62, v110, v182
    v_fmac_f32 v63, v111, v182
    v_cvt_pk_bf16_f32 v112, v16, v17
    v_cvt_pk_bf16_f32 v113, v18, v19
    v_cvt_pk_bf16_f32 v114, v20, v21
    v_cvt_pk_bf16_f32 v115, v22, v23
    s_nop 1
    v_permlane32_swap_b32 v112, v114
    v_permlane32_swap_b32 v113, v115
    buffer_store_dwordx4 v[112:115], v241, s[24:27], 0 offen offset:0
    v_cvt_pk_bf16_f32 v116, v24, v25
    v_cvt_pk_bf16_f32 v117, v26, v27
    v_cvt_pk_bf16_f32 v118, v28, v29
    v_cvt_pk_bf16_f32 v119, v30, v31
    s_nop 1
    v_permlane32_swap_b32 v116, v118
    v_permlane32_swap_b32 v117, v119
    buffer_store_dwordx4 v[116:119], v241, s[24:27], 0 offen offset:32
    v_add_u32 v8, 8192, v241
    v_cvt_pk_bf16_f32 v120, v32, v33
    v_cvt_pk_bf16_f32 v121, v34, v35
    v_cvt_pk_bf16_f32 v122, v36, v37
    v_cvt_pk_bf16_f32 v123, v38, v39
    s_nop 1
    v_permlane32_swap_b32 v120, v122
    v_permlane32_swap_b32 v121, v123
    buffer_store_dwordx4 v[120:123], v8, s[24:27], 0 offen offset:0
    v_cvt_pk_bf16_f32 v124, v40, v41
    v_cvt_pk_bf16_f32 v125, v42, v43
    v_cvt_pk_bf16_f32 v126, v44, v45
    v_cvt_pk_bf16_f32 v127, v46, v47
    s_nop 1
    v_permlane32_swap_b32 v124, v126
    v_permlane32_swap_b32 v125, v127
    buffer_store_dwordx4 v[124:127], v8, s[24:27], 0 offen offset:32
    v_add_u32 v8, 16384, v241
    v_cvt_pk_bf16_f32 v128, v48, v49
    v_cvt_pk_bf16_f32 v129, v50, v51
    v_cvt_pk_bf16_f32 v130, v52, v53
    v_cvt_pk_bf16_f32 v131, v54, v55
    s_nop 1
    v_permlane32_swap_b32 v128, v130
    v_permlane32_swap_b32 v129, v131
    buffer_store_dwordx4 v[128:131], v8, s[24:27], 0 offen offset:0
    v_cvt_pk_bf16_f32 v132, v56, v57
    v_cvt_pk_bf16_f32 v133, v58, v59
    v_cvt_pk_bf16_f32 v134, v60, v61
    v_cvt_pk_bf16_f32 v135, v62, v63
    s_nop 1
    v_permlane32_swap_b32 v132, v134
    v_permlane32_swap_b32 v133, v135
    buffer_store_dwordx4 v[132:135], v8, s[24:27], 0 offen offset:32
    s_endpgm
EPI_3:
    ds_write_b128 v7, a[0:3] offset:1024
    ds_write_b128 v7, a[4:7] offset:2048
    ds_write_b128 v7, a[8:11] offset:3072
    ds_write_b128 v7, a[12:15] offset:4096
    ds_write_b128 v7, a[16:19] offset:13312
    ds_write_b128 v7, a[20:23] offset:14336
    ds_write_b128 v7, a[24:27] offset:15360
    ds_write_b128 v7, a[28:31] offset:16384
    ds_write_b128 v7, a[32:35] offset:25600
    ds_write_b128 v7, a[36:39] offset:26624
    ds_write_b128 v7, a[40:43] offset:27648
    ds_write_b128 v7, a[44:47] offset:28672
    v_accvgpr_read_b32 v16, a48
    v_accvgpr_read_b32 v17, a49
    v_accvgpr_read_b32 v18, a50
    v_accvgpr_read_b32 v19, a51
    v_accvgpr_read_b32 v20, a52
    v_accvgpr_read_b32 v21, a53
    v_accvgpr_read_b32 v22, a54
    v_accvgpr_read_b32 v23, a55
    v_accvgpr_read_b32 v24, a56
    v_accvgpr_read_b32 v25, a57
    v_accvgpr_read_b32 v26, a58
    v_accvgpr_read_b32 v27, a59
    v_accvgpr_read_b32 v28, a60
    v_accvgpr_read_b32 v29, a61
    v_accvgpr_read_b32 v30, a62
    v_accvgpr_read_b32 v31, a63
    ds_write_b128 v7, a[64:67] offset:5120
    ds_write_b128 v7, a[68:71] offset:6144
    ds_write_b128 v7, a[72:75] offset:7168
    ds_write_b128 v7, a[76:79] offset:8192
    ds_write_b128 v7, a[80:83] offset:17408
    ds_write_b128 v7, a[84:87] offset:18432
    ds_write_b128 v7, a[88:91] offset:19456
    ds_write_b128 v7, a[92:95] offset:20480
    ds_write_b128 v7, a[96:99] offset:29696
    ds_write_b128 v7, a[100:103] offset:30720
    ds_write_b128 v7, a[104:107] offset:31744
    ds_write_b128 v7, a[108:111] offset:32768
    v_accvgpr_read_b32 v32, a112
    v_accvgpr_read_b32 v33, a113
    v_accvgpr_read_b32 v34, a114
    v_accvgpr_read_b32 v35, a115
    v_accvgpr_read_b32 v36, a116
    v_accvgpr_read_b32 v37, a117
    v_accvgpr_read_b32 v38, a118
    v_accvgpr_read_b32 v39, a119
    v_accvgpr_read_b32 v40, a120
    v_accvgpr_read_b32 v41, a121
    v_accvgpr_read_b32 v42, a122
    v_accvgpr_read_b32 v43, a123
    v_accvgpr_read_b32 v44, a124
    v_accvgpr_read_b32 v45, a125
    v_accvgpr_read_b32 v46, a126
    v_accvgpr_read_b32 v47, a127
    s_nop 7
    ds_write_b128 v7, a[128:131] offset:9216
    ds_write_b128 v7, a[132:135] offset:10240
    ds_write_b128 v7, a[136:139] offset:11264
    ds_write_b128 v7, a[140:143] offset:12288
    ds_write_b128 v7, a[144:147] offset:21504
    ds_write_b128 v7, a[148:151] offset:22528
    ds_write_b128 v7, a[152:155] offset:23552
    ds_write_b128 v7, a[156:159] offset:24576
    ds_write_b128 v7, a[160:163] offset:33792
    ds_write_b128 v7, a[164:167] offset:34816
    ds_write_b128 v7, a[168:171] offset:35840
    ds_write_b128 v7, a[172:175] offset:36864
    v_accvgpr_read_b32 v48, a176
    v_accvgpr_read_b32 v49, a177
    v_accvgpr_read_b32 v50, a178
    v_accvgpr_read_b32 v51, a179
    v_accvgpr_read_b32 v52, a180
    v_accvgpr_read_b32 v53, a181
    v_accvgpr_read_b32 v54, a182
    v_accvgpr_read_b32 v55, a183
    v_accvgpr_read_b32 v56, a184
    v_accvgpr_read_b32 v57, a185
    v_accvgpr_read_b32 v58, a186
    v_accvgpr_read_b32 v59, a187
    v_accvgpr_read_b32 v60, a188
    v_accvgpr_read_b32 v61, a189
    v_accvgpr_read_b32 v62, a190
    v_accvgpr_read_b32 v63, a191
    s_waitcnt lgkmcnt(0)
    s_barrier
    ds_read_b64 v[160:161], v4 offset:0
    ds_read_b64 v[162:163], v4 offset:40960
    v_add_u32 v8, 81920, v4
    ds_read_b64 v[164:165], v8 offset:0
    v_add_u32 v8, 122880, v4
    ds_read_b64 v[166:167], v8 offset:0
    ds_read_b64 v[168:169], v4 offset:256
    ds_read_b64 v[170:171], v4 offset:41216
    v_add_u32 v8, 81920, v4
    ds_read_b64 v[172:173], v8 offset:256
    v_add_u32 v8, 122880, v4
    ds_read_b64 v[174:175], v8 offset:256
    ds_read_b64 v[176:177], v4 offset:512
    ds_read_b64 v[178:179], v4 offset:41472
    v_add_u32 v8, 81920, v4
    ds_read_b64 v[180:181], v8 offset:512
    v_add_u32 v8, 122880, v4
    ds_read_b64 v[182:183], v8 offset:512
    v_add_u32 v9, 0, v6
    v_add_u32 v10, 40960, v6
    v_add_u32 v11, 81920, v6
    ds_read_b128 v[64:67], v9 offset:25600
    ds_read_b128 v[68:71], v9 offset:26624
    ds_read_b128 v[72:75], v9 offset:27648
    ds_read_b128 v[76:79], v9 offset:28672
    ds_read_b128 v[80:83], v9 offset:29696
    ds_read_b128 v[84:87], v9 offset:30720
    ds_read_b128 v[88:91], v9 offset:31744
    ds_read_b128 v[92:95], v9 offset:32768
    ds_read_b128 v[96:99], v9 offset:33792
    ds_read_b128 v[100:103], v9 offset:34816
    ds_read_b128 v[104:107], v9 offset:35840
    ds_read_b128 v[108:111], v9 offset:36864
    s_waitcnt lgkmcnt(12)
    v_max_f32 v212, v160, v162
    v_max3_f32 v212, v212, v164, v166
    v_sub_f32 v160, v160, v212
    v_exp_f32 v160, v160
    v_sub_f32 v162, v162, v212
    v_exp_f32 v162, v162
    v_sub_f32 v164, v164, v212
    v_exp_f32 v164, v164
    v_sub_f32 v166, v166, v212
    v_exp_f32 v166, v166
    s_nop 0
    v_mul_f32 v213, v160, v161
    v_fmac_f32 v213, v162, v163
    v_fmac_f32 v213, v164, v165
    v_fmac_f32 v213, v166, v167
    v_rcp_f32 v213, v213
    s_nop 0
    v_mul_f32 v160, v160, v213
    v_mul_f32 v162, v162, v213
    v_mul_f32 v164, v164, v213
    v_mul_f32 v166, v166, v213
    v_max_f32 v212, v168, v170
    v_max3_f32 v212, v212, v172, v174
    v_sub_f32 v168, v168, v212
    v_exp_f32 v168, v168
    v_sub_f32 v170, v170, v212
    v_exp_f32 v170, v170
    v_sub_f32 v172, v172, v212
    v_exp_f32 v172, v172
    v_sub_f32 v174, v174, v212
    v_exp_f32 v174, v174
    s_nop 0
    v_mul_f32 v213, v168, v169
    v_fmac_f32 v213, v170, v171
    v_fmac_f32 v213, v172, v173
    v_fmac_f32 v213, v174, v175
    v_rcp_f32 v213, v213
    s_nop 0
    v_mul_f32 v168, v168, v213
    v_mul_f32 v170, v170, v213
    v_mul_f32 v172, v172, v213
    v_mul_f32 v174, v174, v213
    v_max_f32 v212, v176, v178
    v_max3_f32 v212, v212, v180, v182
    v_sub_f32 v176, v176, v212
    v_exp_f32 v176, v176
    v_sub_f32 v178, v178, v212
    v_exp_f32 v178, v178
    v_sub_f32 v180, v180, v212
    v_exp_f32 v180, v180
    v_sub_f32 v182, v182, v212
    v_exp_f32 v182, v182
    s_nop 0
    v_mul_f32 v213, v176, v177
    v_fmac_f32 v213, v178, v179
    v_fmac_f32 v213, v180, v181
    v_fmac_f32 v213, v182, v183
    v_rcp_f32 v213, v213
    s_nop 0
    v_mul_f32 v176, v176, v213
    v_mul_f32 v178, v178, v213
    v_mul_f32 v180, v180, v213
    v_mul_f32 v182, v182, v213
    v_mul_f32 v16, v16, v166
    v_mul_f32 v17, v17, v166
    v_mul_f32 v18, v18, v166
    v_mul_f32 v19, v19, v166
    v_mul_f32 v20, v20, v166
    v_mul_f32 v21, v21, v166
    v_mul_f32 v22, v22, v166
    v_mul_f32 v23, v23, v166
    v_mul_f32 v24, v24, v166
    v_mul_f32 v25, v25, v166
    v_mul_f32 v26, v26, v166
    v_mul_f32 v27, v27, v166
    v_mul_f32 v28, v28, v166
    v_mul_f32 v29, v29, v166
    v_mul_f32 v30, v30, v166
    v_mul_f32 v31, v31, v166
    v_mul_f32 v32, v32, v174
    v_mul_f32 v33, v33, v174
    v_mul_f32 v34, v34, v174
    v_mul_f32 v35, v35, v174
    v_mul_f32 v36, v36, v174
    v_mul_f32 v37, v37, v174
    v_mul_f32 v38, v38, v174
    v_mul_f32 v39, v39, v174
    v_mul_f32 v40, v40, v174
    v_mul_f32 v41, v41, v174
    v_mul_f32 v42, v42, v174
    v_mul_f32 v43, v43, v174
    v_mul_f32 v44, v44, v174
    v_mul_f32 v45, v45, v174
    v_mul_f32 v46, v46, v174
    v_mul_f32 v47, v47, v174
    v_mul_f32 v48, v48, v182
    v_mul_f32 v49, v49, v182
    v_mul_f32 v50, v50, v182
    v_mul_f32 v51, v51, v182
    v_mul_f32 v52, v52, v182
    v_mul_f32 v53, v53, v182
    v_mul_f32 v54, v54, v182
    v_mul_f32 v55, v55, v182
    v_mul_f32 v56, v56, v182
    v_mul_f32 v57, v57, v182
    v_mul_f32 v58, v58, v182
    v_mul_f32 v59, v59, v182
    v_mul_f32 v60, v60, v182
    v_mul_f32 v61, v61, v182
    v_mul_f32 v62, v62, v182
    v_mul_f32 v63, v63, v182
    ds_read_b128 v[112:115], v10 offset:25600
    ds_read_b128 v[116:119], v10 offset:26624
    ds_read_b128 v[120:123], v10 offset:27648
    ds_read_b128 v[124:127], v10 offset:28672
    ds_read_b128 v[128:131], v10 offset:29696
    ds_read_b128 v[132:135], v10 offset:30720
    ds_read_b128 v[136:139], v10 offset:31744
    ds_read_b128 v[140:143], v10 offset:32768
    ds_read_b128 v[144:147], v10 offset:33792
    ds_read_b128 v[148:151], v10 offset:34816
    ds_read_b128 v[152:155], v10 offset:35840
    ds_read_b128 v[156:159], v10 offset:36864
    s_waitcnt lgkmcnt(12)
    v_fmac_f32 v16, v64, v160
    v_fmac_f32 v17, v65, v160
    v_fmac_f32 v18, v66, v160
    v_fmac_f32 v19, v67, v160
    v_fmac_f32 v20, v68, v160
    v_fmac_f32 v21, v69, v160
    v_fmac_f32 v22, v70, v160
    v_fmac_f32 v23, v71, v160
    v_fmac_f32 v24, v72, v160
    v_fmac_f32 v25, v73, v160
    v_fmac_f32 v26, v74, v160
    v_fmac_f32 v27, v75, v160
    v_fmac_f32 v28, v76, v160
    v_fmac_f32 v29, v77, v160
    v_fmac_f32 v30, v78, v160
    v_fmac_f32 v31, v79, v160
    v_fmac_f32 v32, v80, v168
    v_fmac_f32 v33, v81, v168
    v_fmac_f32 v34, v82, v168
    v_fmac_f32 v35, v83, v168
    v_fmac_f32 v36, v84, v168
    v_fmac_f32 v37, v85, v168
    v_fmac_f32 v38, v86, v168
    v_fmac_f32 v39, v87, v168
    v_fmac_f32 v40, v88, v168
    v_fmac_f32 v41, v89, v168
    v_fmac_f32 v42, v90, v168
    v_fmac_f32 v43, v91, v168
    v_fmac_f32 v44, v92, v168
    v_fmac_f32 v45, v93, v168
    v_fmac_f32 v46, v94, v168
    v_fmac_f32 v47, v95, v168
    v_fmac_f32 v48, v96, v176
    v_fmac_f32 v49, v97, v176
    v_fmac_f32 v50, v98, v176
    v_fmac_f32 v51, v99, v176
    v_fmac_f32 v52, v100, v176
    v_fmac_f32 v53, v101, v176
    v_fmac_f32 v54, v102, v176
    v_fmac_f32 v55, v103, v176
    v_fmac_f32 v56, v104, v176
    v_fmac_f32 v57, v105, v176
    v_fmac_f32 v58, v106, v176
    v_fmac_f32 v59, v107, v176
    v_fmac_f32 v60, v108, v176
    v_fmac_f32 v61, v109, v176
    v_fmac_f32 v62, v110, v176
    v_fmac_f32 v63, v111, v176
    ds_read_b128 v[64:67], v11 offset:25600
    ds_read_b128 v[68:71], v11 offset:26624
    ds_read_b128 v[72:75], v11 offset:27648
    ds_read_b128 v[76:79], v11 offset:28672
    ds_read_b128 v[80:83], v11 offset:29696
    ds_read_b128 v[84:87], v11 offset:30720
    ds_read_b128 v[88:91], v11 offset:31744
    ds_read_b128 v[92:95], v11 offset:32768
    ds_read_b128 v[96:99], v11 offset:33792
    ds_read_b128 v[100:103], v11 offset:34816
    ds_read_b128 v[104:107], v11 offset:35840
    ds_read_b128 v[108:111], v11 offset:36864
    s_waitcnt lgkmcnt(12)
    v_fmac_f32 v16, v112, v162
    v_fmac_f32 v17, v113, v162
    v_fmac_f32 v18, v114, v162
    v_fmac_f32 v19, v115, v162
    v_fmac_f32 v20, v116, v162
    v_fmac_f32 v21, v117, v162
    v_fmac_f32 v22, v118, v162
    v_fmac_f32 v23, v119, v162
    v_fmac_f32 v24, v120, v162
    v_fmac_f32 v25, v121, v162
    v_fmac_f32 v26, v122, v162
    v_fmac_f32 v27, v123, v162
    v_fmac_f32 v28, v124, v162
    v_fmac_f32 v29, v125, v162
    v_fmac_f32 v30, v126, v162
    v_fmac_f32 v31, v127, v162
    v_fmac_f32 v32, v128, v170
    v_fmac_f32 v33, v129, v170
    v_fmac_f32 v34, v130, v170
    v_fmac_f32 v35, v131, v170
    v_fmac_f32 v36, v132, v170
    v_fmac_f32 v37, v133, v170
    v_fmac_f32 v38, v134, v170
    v_fmac_f32 v39, v135, v170
    v_fmac_f32 v40, v136, v170
    v_fmac_f32 v41, v137, v170
    v_fmac_f32 v42, v138, v170
    v_fmac_f32 v43, v139, v170
    v_fmac_f32 v44, v140, v170
    v_fmac_f32 v45, v141, v170
    v_fmac_f32 v46, v142, v170
    v_fmac_f32 v47, v143, v170
    v_fmac_f32 v48, v144, v178
    v_fmac_f32 v49, v145, v178
    v_fmac_f32 v50, v146, v178
    v_fmac_f32 v51, v147, v178
    v_fmac_f32 v52, v148, v178
    v_fmac_f32 v53, v149, v178
    v_fmac_f32 v54, v150, v178
    v_fmac_f32 v55, v151, v178
    v_fmac_f32 v56, v152, v178
    v_fmac_f32 v57, v153, v178
    v_fmac_f32 v58, v154, v178
    v_fmac_f32 v59, v155, v178
    v_fmac_f32 v60, v156, v178
    v_fmac_f32 v61, v157, v178
    v_fmac_f32 v62, v158, v178
    v_fmac_f32 v63, v159, v178
    s_waitcnt lgkmcnt(0)
    v_fmac_f32 v16, v64, v164
    v_fmac_f32 v17, v65, v164
    v_fmac_f32 v18, v66, v164
    v_fmac_f32 v19, v67, v164
    v_fmac_f32 v20, v68, v164
    v_fmac_f32 v21, v69, v164
    v_fmac_f32 v22, v70, v164
    v_fmac_f32 v23, v71, v164
    v_fmac_f32 v24, v72, v164
    v_fmac_f32 v25, v73, v164
    v_fmac_f32 v26, v74, v164
    v_fmac_f32 v27, v75, v164
    v_fmac_f32 v28, v76, v164
    v_fmac_f32 v29, v77, v164
    v_fmac_f32 v30, v78, v164
    v_fmac_f32 v31, v79, v164
    v_fmac_f32 v32, v80, v172
    v_fmac_f32 v33, v81, v172
    v_fmac_f32 v34, v82, v172
    v_fmac_f32 v35, v83, v172
    v_fmac_f32 v36, v84, v172
    v_fmac_f32 v37, v85, v172
    v_fmac_f32 v38, v86, v172
    v_fmac_f32 v39, v87, v172
    v_fmac_f32 v40, v88, v172
    v_fmac_f32 v41, v89, v172
    v_fmac_f32 v42, v90, v172
    v_fmac_f32 v43, v91, v172
    v_fmac_f32 v44, v92, v172
    v_fmac_f32 v45, v93, v172
    v_fmac_f32 v46, v94, v172
    v_fmac_f32 v47, v95, v172
    v_fmac_f32 v48, v96, v180
    v_fmac_f32 v49, v97, v180
    v_fmac_f32 v50, v98, v180
    v_fmac_f32 v51, v99, v180
    v_fmac_f32 v52, v100, v180
    v_fmac_f32 v53, v101, v180
    v_fmac_f32 v54, v102, v180
    v_fmac_f32 v55, v103, v180
    v_fmac_f32 v56, v104, v180
    v_fmac_f32 v57, v105, v180
    v_fmac_f32 v58, v106, v180
    v_fmac_f32 v59, v107, v180
    v_fmac_f32 v60, v108, v180
    v_fmac_f32 v61, v109, v180
    v_fmac_f32 v62, v110, v180
    v_fmac_f32 v63, v111, v180
    v_cvt_pk_bf16_f32 v112, v16, v17
    v_cvt_pk_bf16_f32 v113, v18, v19
    v_cvt_pk_bf16_f32 v114, v20, v21
    v_cvt_pk_bf16_f32 v115, v22, v23
    s_nop 1
    v_permlane32_swap_b32 v112, v114
    v_permlane32_swap_b32 v113, v115
    buffer_store_dwordx4 v[112:115], v241, s[24:27], 0 offen offset:0
    v_cvt_pk_bf16_f32 v116, v24, v25
    v_cvt_pk_bf16_f32 v117, v26, v27
    v_cvt_pk_bf16_f32 v118, v28, v29
    v_cvt_pk_bf16_f32 v119, v30, v31
    s_nop 1
    v_permlane32_swap_b32 v116, v118
    v_permlane32_swap_b32 v117, v119
    buffer_store_dwordx4 v[116:119], v241, s[24:27], 0 offen offset:32
    v_add_u32 v8, 8192, v241
    v_cvt_pk_bf16_f32 v120, v32, v33
    v_cvt_pk_bf16_f32 v121, v34, v35
    v_cvt_pk_bf16_f32 v122, v36, v37
    v_cvt_pk_bf16_f32 v123, v38, v39
    s_nop 1
    v_permlane32_swap_b32 v120, v122
    v_permlane32_swap_b32 v121, v123
    buffer_store_dwordx4 v[120:123], v8, s[24:27], 0 offen offset:0
    v_cvt_pk_bf16_f32 v124, v40, v41
    v_cvt_pk_bf16_f32 v125, v42, v43
    v_cvt_pk_bf16_f32 v126, v44, v45
    v_cvt_pk_bf16_f32 v127, v46, v47
    s_nop 1
    v_permlane32_swap_b32 v124, v126
    v_permlane32_swap_b32 v125, v127
    buffer_store_dwordx4 v[124:127], v8, s[24:27], 0 offen offset:32
    v_add_u32 v8, 16384, v241
    v_cvt_pk_bf16_f32 v128, v48, v49
    v_cvt_pk_bf16_f32 v129, v50, v51
    v_cvt_pk_bf16_f32 v130, v52, v53
    v_cvt_pk_bf16_f32 v131, v54, v55
    s_nop 1
    v_permlane32_swap_b32 v128, v130
    v_permlane32_swap_b32 v129, v131
    buffer_store_dwordx4 v[128:131], v8, s[24:27], 0 offen offset:0
    v_cvt_pk_bf16_f32 v132, v56, v57
    v_cvt_pk_bf16_f32 v133, v58, v59
    v_cvt_pk_bf16_f32 v134, v60, v61
    v_cvt_pk_bf16_f32 v135, v62, v63
    s_nop 1
    v_permlane32_swap_b32 v132, v134
    v_permlane32_swap_b32 v133, v135
    buffer_store_dwordx4 v[132:135], v8, s[24:27], 0 offen offset:32
    s_endpgm
L_END:
    s_endpgm
RARE_0_0:
    v_mov_b32 v213, v212
    s_nop 1
    v_permlane32_swap_b32 v212, v213
    v_max_f32 v212, v212, v213
    v_add_f32 v212, v212, v203
    v_cvt_pk_bf16_f32 v213, v212, v212
    v_lshlrev_b32 v213, 16, v213
    v_max_f32 v213, v213, v200
    v_sub_f32 v214, v203, v213
    v_sub_f32 v215, v200, v213
    v_exp_f32 v215, v215
    v_mov_b32 v200, v213
    v_mov_b32 v203, v213
    v_cvt_pk_bf16_f32 v184, -v213, 0
    v_mov_b32 v206, 0x41000000
    v_mul_f32 v209, v209, v215
    v_add_f32 v16, v16, v214
    v_add_f32 v17, v17, v214
    v_add_f32 v18, v18, v214
    v_add_f32 v19, v19, v214
    v_add_f32 v20, v20, v214
    v_add_f32 v21, v21, v214
    v_add_f32 v22, v22, v214
    v_add_f32 v23, v23, v214
    v_add_f32 v24, v24, v214
    v_add_f32 v25, v25, v214
    v_add_f32 v26, v26, v214
    v_add_f32 v27, v27, v214
    v_add_f32 v28, v28, v214
    v_add_f32 v29, v29, v214
    v_add_f32 v30, v30, v214
    v_add_f32 v31, v31, v214
    v_accvgpr_read_b32 v216, a0
    v_mul_f32 v216, v216, v215
    v_accvgpr_write_b32 a0, v216
    v_accvgpr_read_b32 v217, a1
    v_mul_f32 v217, v217, v215
    v_accvgpr_write_b32 a1, v217
    v_accvgpr_read_b32 v218, a2
    v_mul_f32 v218, v218, v215
    v_accvgpr_write_b32 a2, v218
    v_accvgpr_read_b32 v219, a3
    v_mul_f32 v219, v219, v215
    v_accvgpr_write_b32 a3, v219
    v_accvgpr_read_b32 v216, a4
    v_mul_f32 v216, v216, v215
    v_accvgpr_write_b32 a4, v216
    v_accvgpr_read_b32 v217, a5
    v_mul_f32 v217, v217, v215
    v_accvgpr_write_b32 a5, v217
    v_accvgpr_read_b32 v218, a6
    v_mul_f32 v218, v218, v215
    v_accvgpr_write_b32 a6, v218
    v_accvgpr_read_b32 v219, a7
    v_mul_f32 v219, v219, v215
    v_accvgpr_write_b32 a7, v219
    v_accvgpr_read_b32 v216, a8
    v_mul_f32 v216, v216, v215
    v_accvgpr_write_b32 a8, v216
    v_accvgpr_read_b32 v217, a9
    v_mul_f32 v217, v217, v215
    v_accvgpr_write_b32 a9, v217
    v_accvgpr_read_b32 v218, a10
    v_mul_f32 v218, v218, v215
    v_accvgpr_write_b32 a10, v218
    v_accvgpr_read_b32 v219, a11
    v_mul_f32 v219, v219, v215
    v_accvgpr_write_b32 a11, v219
    v_accvgpr_read_b32 v216, a12
    v_mul_f32 v216, v216, v215
    v_accvgpr_write_b32 a12, v216
    v_accvgpr_read_b32 v217, a13
    v_mul_f32 v217, v217, v215
    v_accvgpr_write_b32 a13, v217
    v_accvgpr_read_b32 v218, a14
    v_mul_f32 v218, v218, v215
    v_accvgpr_write_b32 a14, v218
    v_accvgpr_read_b32 v219, a15
    v_mul_f32 v219, v219, v215
    v_accvgpr_write_b32 a15, v219
    v_accvgpr_read_b32 v216, a16
    v_mul_f32 v216, v216, v215
    v_accvgpr_write_b32 a16, v216
    v_accvgpr_read_b32 v217, a17
    v_mul_f32 v217, v217, v215
    v_accvgpr_write_b32 a17, v217
    v_accvgpr_read_b32 v218, a18
    v_mul_f32 v218, v218, v215
    v_accvgpr_write_b32 a18, v218
    v_accvgpr_read_b32 v219, a19
    v_mul_f32 v219, v219, v215
    v_accvgpr_write_b32 a19, v219
    v_accvgpr_read_b32 v216, a20
    v_mul_f32 v216, v216, v215
    v_accvgpr_write_b32 a20, v216
    v_accvgpr_read_b32 v217, a21
    v_mul_f32 v217, v217, v215
    v_accvgpr_write_b32 a21, v217
    v_accvgpr_read_b32 v218, a22
    v_mul_f32 v218, v218, v215
    v_accvgpr_write_b32 a22, v218
    v_accvgpr_read_b32 v219, a23
    v_mul_f32 v219, v219, v215
    v_accvgpr_write_b32 a23, v219
    v_accvgpr_read_b32 v216, a24
    v_mul_f32 v216, v216, v215
    v_accvgpr_write_b32 a24, v216
    v_accvgpr_read_b32 v217, a25
    v_mul_f32 v217, v217, v215
    v_accvgpr_write_b32 a25, v217
    v_accvgpr_read_b32 v218, a26
    v_mul_f32 v218, v218, v215
    v_accvgpr_write_b32 a26, v218
    v_accvgpr_read_b32 v219, a27
    v_mul_f32 v219, v219, v215
    v_accvgpr_write_b32 a27, v219
    v_accvgpr_read_b32 v216, a28
    v_mul_f32 v216, v216, v215
    v_accvgpr_write_b32 a28, v216
    v_accvgpr_read_b32 v217, a29
    v_mul_f32 v217, v217, v215
    v_accvgpr_write_b32 a29, v217
    v_accvgpr_read_b32 v218, a30
    v_mul_f32 v218, v218, v215
    v_accvgpr_write_b32 a30, v218
    v_accvgpr_read_b32 v219, a31
    v_mul_f32 v219, v219, v215
    v_accvgpr_write_b32 a31, v219
    v_accvgpr_read_b32 v216, a32
    v_mul_f32 v216, v216, v215
    v_accvgpr_write_b32 a32, v216
    v_accvgpr_read_b32 v217, a33
    v_mul_f32 v217, v217, v215
    v_accvgpr_write_b32 a33, v217
    v_accvgpr_read_b32 v218, a34
    v_mul_f32 v218, v218, v215
    v_accvgpr_write_b32 a34, v218
    v_accvgpr_read_b32 v219, a35
    v_mul_f32 v219, v219, v215
    v_accvgpr_write_b32 a35, v219
    v_accvgpr_read_b32 v216, a36
    v_mul_f32 v216, v216, v215
    v_accvgpr_write_b32 a36, v216
    v_accvgpr_read_b32 v217, a37
    v_mul_f32 v217, v217, v215
    v_accvgpr_write_b32 a37, v217
    v_accvgpr_read_b32 v218, a38
    v_mul_f32 v218, v218, v215
    v_accvgpr_write_b32 a38, v218
    v_accvgpr_read_b32 v219, a39
    v_mul_f32 v219, v219, v215
    v_accvgpr_write_b32 a39, v219
    v_accvgpr_read_b32 v216, a40
    v_mul_f32 v216, v216, v215
    v_accvgpr_write_b32 a40, v216
    v_accvgpr_read_b32 v217, a41
    v_mul_f32 v217, v217, v215
    v_accvgpr_write_b32 a41, v217
    v_accvgpr_read_b32 v218, a42
    v_mul_f32 v218, v218, v215
    v_accvgpr_write_b32 a42, v218
    v_accvgpr_read_b32 v219, a43
    v_mul_f32 v219, v219, v215
    v_accvgpr_write_b32 a43, v219
    v_accvgpr_read_b32 v216, a44
    v_mul_f32 v216, v216, v215
    v_accvgpr_write_b32 a44, v216
    v_accvgpr_read_b32 v217, a45
    v_mul_f32 v217, v217, v215
    v_accvgpr_write_b32 a45, v217
    v_accvgpr_read_b32 v218, a46
    v_mul_f32 v218, v218, v215
    v_accvgpr_write_b32 a46, v218
    v_accvgpr_read_b32 v219, a47
    v_mul_f32 v219, v219, v215
    v_accvgpr_write_b32 a47, v219
    v_accvgpr_read_b32 v216, a48
    v_mul_f32 v216, v216, v215
    v_accvgpr_write_b32 a48, v216
    v_accvgpr_read_b32 v217, a49
    v_mul_f32 v217, v217, v215
    v_accvgpr_write_b32 a49, v217
    v_accvgpr_read_b32 v218, a50
    v_mul_f32 v218, v218, v215
    v_accvgpr_write_b32 a50, v218
    v_accvgpr_read_b32 v219, a51
    v_mul_f32 v219, v219, v215
    v_accvgpr_write_b32 a51, v219
    v_accvgpr_read_b32 v216, a52
    v_mul_f32 v216, v216, v215
    v_accvgpr_write_b32 a52, v216
    v_accvgpr_read_b32 v217, a53
    v_mul_f32 v217, v217, v215
    v_accvgpr_write_b32 a53, v217
    v_accvgpr_read_b32 v218, a54
    v_mul_f32 v218, v218, v215
    v_accvgpr_write_b32 a54, v218
    v_accvgpr_read_b32 v219, a55
    v_mul_f32 v219, v219, v215
    v_accvgpr_write_b32 a55, v219
    v_accvgpr_read_b32 v216, a56
    v_mul_f32 v216, v216, v215
    v_accvgpr_write_b32 a56, v216
    v_accvgpr_read_b32 v217, a57
    v_mul_f32 v217, v217, v215
    v_accvgpr_write_b32 a57, v217
    v_accvgpr_read_b32 v218, a58
    v_mul_f32 v218, v218, v215
    v_accvgpr_write_b32 a58, v218
    v_accvgpr_read_b32 v219, a59
    v_mul_f32 v219, v219, v215
    v_accvgpr_write_b32 a59, v219
    v_accvgpr_read_b32 v216, a60
    v_mul_f32 v216, v216, v215
    v_accvgpr_write_b32 a60, v216
    v_accvgpr_read_b32 v217, a61
    v_mul_f32 v217, v217, v215
    v_accvgpr_write_b32 a61, v217
    v_accvgpr_read_b32 v218, a62
    v_mul_f32 v218, v218, v215
    v_accvgpr_write_b32 a62, v218
    v_accvgpr_read_b32 v219, a63
    v_mul_f32 v219, v219, v215
    v_accvgpr_write_b32 a63, v219
    s_branch BACK_0_0
RARE_0_1:
    v_mov_b32 v213, v212
    s_nop 1
    v_permlane32_swap_b32 v212, v213
    v_max_f32 v212, v212, v213
    v_add_f32 v212, v212, v204
    v_cvt_pk_bf16_f32 v213, v212, v212
    v_lshlrev_b32 v213, 16, v213
    v_max_f32 v213, v213, v201
    v_sub_f32 v214, v204, v213
    v_sub_f32 v215, v201, v213
    v_exp_f32 v215, v215
    v_mov_b32 v201, v213
    v_mov_b32 v204, v213
    v_cvt_pk_bf16_f32 v188, -v213, 0
    v_mov_b32 v207, 0x41000000
    v_mul_f32 v210, v210, v215
    v_add_f32 v32, v32, v214
    v_add_f32 v33, v33, v214
    v_add_f32 v34, v34, v214
    v_add_f32 v35, v35, v214
    v_add_f32 v36, v36, v214
    v_add_f32 v37, v37, v214
    v_add_f32 v38, v38, v214
    v_add_f32 v39, v39, v214
    v_add_f32 v40, v40, v214
    v_add_f32 v41, v41, v214
    v_add_f32 v42, v42, v214
    v_add_f32 v43, v43, v214
    v_add_f32 v44, v44, v214
    v_add_f32 v45, v45, v214
    v_add_f32 v46, v46, v214
    v_add_f32 v47, v47, v214
    v_accvgpr_read_b32 v216, a64
    v_mul_f32 v216, v216, v215
    v_accvgpr_write_b32 a64, v216
    v_accvgpr_read_b32 v217, a65
    v_mul_f32 v217, v217, v215
    v_accvgpr_write_b32 a65, v217
    v_accvgpr_read_b32 v218, a66
    v_mul_f32 v218, v218, v215
    v_accvgpr_write_b32 a66, v218
    v_accvgpr_read_b32 v219, a67
    v_mul_f32 v219, v219, v215
    v_accvgpr_write_b32 a67, v219
    v_accvgpr_read_b32 v216, a68
    v_mul_f32 v216, v216, v215
    v_accvgpr_write_b32 a68, v216
    v_accvgpr_read_b32 v217, a69
    v_mul_f32 v217, v217, v215
    v_accvgpr_write_b32 a69, v217
    v_accvgpr_read_b32 v218, a70
    v_mul_f32 v218, v218, v215
    v_accvgpr_write_b32 a70, v218
    v_accvgpr_read_b32 v219, a71
    v_mul_f32 v219, v219, v215
    v_accvgpr_write_b32 a71, v219
    v_accvgpr_read_b32 v216, a72
    v_mul_f32 v216, v216, v215
    v_accvgpr_write_b32 a72, v216
    v_accvgpr_read_b32 v217, a73
    v_mul_f32 v217, v217, v215
    v_accvgpr_write_b32 a73, v217
    v_accvgpr_read_b32 v218, a74
    v_mul_f32 v218, v218, v215
    v_accvgpr_write_b32 a74, v218
    v_accvgpr_read_b32 v219, a75
    v_mul_f32 v219, v219, v215
    v_accvgpr_write_b32 a75, v219
    v_accvgpr_read_b32 v216, a76
    v_mul_f32 v216, v216, v215
    v_accvgpr_write_b32 a76, v216
    v_accvgpr_read_b32 v217, a77
    v_mul_f32 v217, v217, v215
    v_accvgpr_write_b32 a77, v217
    v_accvgpr_read_b32 v218, a78
    v_mul_f32 v218, v218, v215
    v_accvgpr_write_b32 a78, v218
    v_accvgpr_read_b32 v219, a79
    v_mul_f32 v219, v219, v215
    v_accvgpr_write_b32 a79, v219
    v_accvgpr_read_b32 v216, a80
    v_mul_f32 v216, v216, v215
    v_accvgpr_write_b32 a80, v216
    v_accvgpr_read_b32 v217, a81
    v_mul_f32 v217, v217, v215
    v_accvgpr_write_b32 a81, v217
    v_accvgpr_read_b32 v218, a82
    v_mul_f32 v218, v218, v215
    v_accvgpr_write_b32 a82, v218
    v_accvgpr_read_b32 v219, a83
    v_mul_f32 v219, v219, v215
    v_accvgpr_write_b32 a83, v219
    v_accvgpr_read_b32 v216, a84
    v_mul_f32 v216, v216, v215
    v_accvgpr_write_b32 a84, v216
    v_accvgpr_read_b32 v217, a85
    v_mul_f32 v217, v217, v215
    v_accvgpr_write_b32 a85, v217
    v_accvgpr_read_b32 v218, a86
    v_mul_f32 v218, v218, v215
    v_accvgpr_write_b32 a86, v218
    v_accvgpr_read_b32 v219, a87
    v_mul_f32 v219, v219, v215
    v_accvgpr_write_b32 a87, v219
    v_accvgpr_read_b32 v216, a88
    v_mul_f32 v216, v216, v215
    v_accvgpr_write_b32 a88, v216
    v_accvgpr_read_b32 v217, a89
    v_mul_f32 v217, v217, v215
    v_accvgpr_write_b32 a89, v217
    v_accvgpr_read_b32 v218, a90
    v_mul_f32 v218, v218, v215
    v_accvgpr_write_b32 a90, v218
    v_accvgpr_read_b32 v219, a91
    v_mul_f32 v219, v219, v215
    v_accvgpr_write_b32 a91, v219
    v_accvgpr_read_b32 v216, a92
    v_mul_f32 v216, v216, v215
    v_accvgpr_write_b32 a92, v216
    v_accvgpr_read_b32 v217, a93
    v_mul_f32 v217, v217, v215
    v_accvgpr_write_b32 a93, v217
    v_accvgpr_read_b32 v218, a94
    v_mul_f32 v218, v218, v215
    v_accvgpr_write_b32 a94, v218
    v_accvgpr_read_b32 v219, a95
    v_mul_f32 v219, v219, v215
    v_accvgpr_write_b32 a95, v219
    v_accvgpr_read_b32 v216, a96
    v_mul_f32 v216, v216, v215
    v_accvgpr_write_b32 a96, v216
    v_accvgpr_read_b32 v217, a97
    v_mul_f32 v217, v217, v215
    v_accvgpr_write_b32 a97, v217
    v_accvgpr_read_b32 v218, a98
    v_mul_f32 v218, v218, v215
    v_accvgpr_write_b32 a98, v218
    v_accvgpr_read_b32 v219, a99
    v_mul_f32 v219, v219, v215
    v_accvgpr_write_b32 a99, v219
    v_accvgpr_read_b32 v216, a100
    v_mul_f32 v216, v216, v215
    v_accvgpr_write_b32 a100, v216
    v_accvgpr_read_b32 v217, a101
    v_mul_f32 v217, v217, v215
    v_accvgpr_write_b32 a101, v217
    v_accvgpr_read_b32 v218, a102
    v_mul_f32 v218, v218, v215
    v_accvgpr_write_b32 a102, v218
    v_accvgpr_read_b32 v219, a103
    v_mul_f32 v219, v219, v215
    v_accvgpr_write_b32 a103, v219
    v_accvgpr_read_b32 v216, a104
    v_mul_f32 v216, v216, v215
    v_accvgpr_write_b32 a104, v216
    v_accvgpr_read_b32 v217, a105
    v_mul_f32 v217, v217, v215
    v_accvgpr_write_b32 a105, v217
    v_accvgpr_read_b32 v218, a106
    v_mul_f32 v218, v218, v215
    v_accvgpr_write_b32 a106, v218
    v_accvgpr_read_b32 v219, a107
    v_mul_f32 v219, v219, v215
    v_accvgpr_write_b32 a107, v219
    v_accvgpr_read_b32 v216, a108
    v_mul_f32 v216, v216, v215
    v_accvgpr_write_b32 a108, v216
    v_accvgpr_read_b32 v217, a109
    v_mul_f32 v217, v217, v215
    v_accvgpr_write_b32 a109, v217
    v_accvgpr_read_b32 v218, a110
    v_mul_f32 v218, v218, v215
    v_accvgpr_write_b32 a110, v218
    v_accvgpr_read_b32 v219, a111
    v_mul_f32 v219, v219, v215
    v_accvgpr_write_b32 a111, v219
    v_accvgpr_read_b32 v216, a112
    v_mul_f32 v216, v216, v215
    v_accvgpr_write_b32 a112, v216
    v_accvgpr_read_b32 v217, a113
    v_mul_f32 v217, v217, v215
    v_accvgpr_write_b32 a113, v217
    v_accvgpr_read_b32 v218, a114
    v_mul_f32 v218, v218, v215
    v_accvgpr_write_b32 a114, v218
    v_accvgpr_read_b32 v219, a115
    v_mul_f32 v219, v219, v215
    v_accvgpr_write_b32 a115, v219
    v_accvgpr_read_b32 v216, a116
    v_mul_f32 v216, v216, v215
    v_accvgpr_write_b32 a116, v216
    v_accvgpr_read_b32 v217, a117
    v_mul_f32 v217, v217, v215
    v_accvgpr_write_b32 a117, v217
    v_accvgpr_read_b32 v218, a118
    v_mul_f32 v218, v218, v215
    v_accvgpr_write_b32 a118, v218
    v_accvgpr_read_b32 v219, a119
    v_mul_f32 v219, v219, v215
    v_accvgpr_write_b32 a119, v219
    v_accvgpr_read_b32 v216, a120
    v_mul_f32 v216, v216, v215
    v_accvgpr_write_b32 a120, v216
    v_accvgpr_read_b32 v217, a121
    v_mul_f32 v217, v217, v215
    v_accvgpr_write_b32 a121, v217
    v_accvgpr_read_b32 v218, a122
    v_mul_f32 v218, v218, v215
    v_accvgpr_write_b32 a122, v218
    v_accvgpr_read_b32 v219, a123
    v_mul_f32 v219, v219, v215
    v_accvgpr_write_b32 a123, v219
    v_accvgpr_read_b32 v216, a124
    v_mul_f32 v216, v216, v215
    v_accvgpr_write_b32 a124, v216
    v_accvgpr_read_b32 v217, a125
    v_mul_f32 v217, v217, v215
    v_accvgpr_write_b32 a125, v217
    v_accvgpr_read_b32 v218, a126
    v_mul_f32 v218, v218, v215
    v_accvgpr_write_b32 a126, v218
    v_accvgpr_read_b32 v219, a127
    v_mul_f32 v219, v219, v215
    v_accvgpr_write_b32 a127, v219
    s_branch BACK_0_1
RARE_0_2:
    v_mov_b32 v213, v212
    s_nop 1
    v_permlane32_swap_b32 v212, v213
    v_max_f32 v212, v212, v213
    v_add_f32 v212, v212, v205
    v_cvt_pk_bf16_f32 v213, v212, v212
    v_lshlrev_b32 v213, 16, v213
    v_max_f32 v213, v213, v202
    v_sub_f32 v214, v205, v213
    v_sub_f32 v215, v202, v213
    v_exp_f32 v215, v215
    v_mov_b32 v202, v213
    v_mov_b32 v205, v213
    v_cvt_pk_bf16_f32 v192, -v213, 0
    v_mov_b32 v208, 0x41000000
    v_mul_f32 v211, v211, v215
    v_add_f32 v48, v48, v214
    v_add_f32 v49, v49, v214
    v_add_f32 v50, v50, v214
    v_add_f32 v51, v51, v214
    v_add_f32 v52, v52, v214
    v_add_f32 v53, v53, v214
    v_add_f32 v54, v54, v214
    v_add_f32 v55, v55, v214
    v_add_f32 v56, v56, v214
    v_add_f32 v57, v57, v214
    v_add_f32 v58, v58, v214
    v_add_f32 v59, v59, v214
    v_add_f32 v60, v60, v214
    v_add_f32 v61, v61, v214
    v_add_f32 v62, v62, v214
    v_add_f32 v63, v63, v214
    v_accvgpr_read_b32 v216, a128
    v_mul_f32 v216, v216, v215
    v_accvgpr_write_b32 a128, v216
    v_accvgpr_read_b32 v217, a129
    v_mul_f32 v217, v217, v215
    v_accvgpr_write_b32 a129, v217
    v_accvgpr_read_b32 v218, a130
    v_mul_f32 v218, v218, v215
    v_accvgpr_write_b32 a130, v218
    v_accvgpr_read_b32 v219, a131
    v_mul_f32 v219, v219, v215
    v_accvgpr_write_b32 a131, v219
    v_accvgpr_read_b32 v216, a132
    v_mul_f32 v216, v216, v215
    v_accvgpr_write_b32 a132, v216
    v_accvgpr_read_b32 v217, a133
    v_mul_f32 v217, v217, v215
    v_accvgpr_write_b32 a133, v217
    v_accvgpr_read_b32 v218, a134
    v_mul_f32 v218, v218, v215
    v_accvgpr_write_b32 a134, v218
    v_accvgpr_read_b32 v219, a135
    v_mul_f32 v219, v219, v215
    v_accvgpr_write_b32 a135, v219
    v_accvgpr_read_b32 v216, a136
    v_mul_f32 v216, v216, v215
    v_accvgpr_write_b32 a136, v216
    v_accvgpr_read_b32 v217, a137
    v_mul_f32 v217, v217, v215
    v_accvgpr_write_b32 a137, v217
    v_accvgpr_read_b32 v218, a138
    v_mul_f32 v218, v218, v215
    v_accvgpr_write_b32 a138, v218
    v_accvgpr_read_b32 v219, a139
    v_mul_f32 v219, v219, v215
    v_accvgpr_write_b32 a139, v219
    v_accvgpr_read_b32 v216, a140
    v_mul_f32 v216, v216, v215
    v_accvgpr_write_b32 a140, v216
    v_accvgpr_read_b32 v217, a141
    v_mul_f32 v217, v217, v215
    v_accvgpr_write_b32 a141, v217
    v_accvgpr_read_b32 v218, a142
    v_mul_f32 v218, v218, v215
    v_accvgpr_write_b32 a142, v218
    v_accvgpr_read_b32 v219, a143
    v_mul_f32 v219, v219, v215
    v_accvgpr_write_b32 a143, v219
    v_accvgpr_read_b32 v216, a144
    v_mul_f32 v216, v216, v215
    v_accvgpr_write_b32 a144, v216
    v_accvgpr_read_b32 v217, a145
    v_mul_f32 v217, v217, v215
    v_accvgpr_write_b32 a145, v217
    v_accvgpr_read_b32 v218, a146
    v_mul_f32 v218, v218, v215
    v_accvgpr_write_b32 a146, v218
    v_accvgpr_read_b32 v219, a147
    v_mul_f32 v219, v219, v215
    v_accvgpr_write_b32 a147, v219
    v_accvgpr_read_b32 v216, a148
    v_mul_f32 v216, v216, v215
    v_accvgpr_write_b32 a148, v216
    v_accvgpr_read_b32 v217, a149
    v_mul_f32 v217, v217, v215
    v_accvgpr_write_b32 a149, v217
    v_accvgpr_read_b32 v218, a150
    v_mul_f32 v218, v218, v215
    v_accvgpr_write_b32 a150, v218
    v_accvgpr_read_b32 v219, a151
    v_mul_f32 v219, v219, v215
    v_accvgpr_write_b32 a151, v219
    v_accvgpr_read_b32 v216, a152
    v_mul_f32 v216, v216, v215
    v_accvgpr_write_b32 a152, v216
    v_accvgpr_read_b32 v217, a153
    v_mul_f32 v217, v217, v215
    v_accvgpr_write_b32 a153, v217
    v_accvgpr_read_b32 v218, a154
    v_mul_f32 v218, v218, v215
    v_accvgpr_write_b32 a154, v218
    v_accvgpr_read_b32 v219, a155
    v_mul_f32 v219, v219, v215
    v_accvgpr_write_b32 a155, v219
    v_accvgpr_read_b32 v216, a156
    v_mul_f32 v216, v216, v215
    v_accvgpr_write_b32 a156, v216
    v_accvgpr_read_b32 v217, a157
    v_mul_f32 v217, v217, v215
    v_accvgpr_write_b32 a157, v217
    v_accvgpr_read_b32 v218, a158
    v_mul_f32 v218, v218, v215
    v_accvgpr_write_b32 a158, v218
    v_accvgpr_read_b32 v219, a159
    v_mul_f32 v219, v219, v215
    v_accvgpr_write_b32 a159, v219
    v_accvgpr_read_b32 v216, a160
    v_mul_f32 v216, v216, v215
    v_accvgpr_write_b32 a160, v216
    v_accvgpr_read_b32 v217, a161
    v_mul_f32 v217, v217, v215
    v_accvgpr_write_b32 a161, v217
    v_accvgpr_read_b32 v218, a162
    v_mul_f32 v218, v218, v215
    v_accvgpr_write_b32 a162, v218
    v_accvgpr_read_b32 v219, a163
    v_mul_f32 v219, v219, v215
    v_accvgpr_write_b32 a163, v219
    v_accvgpr_read_b32 v216, a164
    v_mul_f32 v216, v216, v215
    v_accvgpr_write_b32 a164, v216
    v_accvgpr_read_b32 v217, a165
    v_mul_f32 v217, v217, v215
    v_accvgpr_write_b32 a165, v217
    v_accvgpr_read_b32 v218, a166
    v_mul_f32 v218, v218, v215
    v_accvgpr_write_b32 a166, v218
    v_accvgpr_read_b32 v219, a167
    v_mul_f32 v219, v219, v215
    v_accvgpr_write_b32 a167, v219
    v_accvgpr_read_b32 v216, a168
    v_mul_f32 v216, v216, v215
    v_accvgpr_write_b32 a168, v216
    v_accvgpr_read_b32 v217, a169
    v_mul_f32 v217, v217, v215
    v_accvgpr_write_b32 a169, v217
    v_accvgpr_read_b32 v218, a170
    v_mul_f32 v218, v218, v215
    v_accvgpr_write_b32 a170, v218
    v_accvgpr_read_b32 v219, a171
    v_mul_f32 v219, v219, v215
    v_accvgpr_write_b32 a171, v219
    v_accvgpr_read_b32 v216, a172
    v_mul_f32 v216, v216, v215
    v_accvgpr_write_b32 a172, v216
    v_accvgpr_read_b32 v217, a173
    v_mul_f32 v217, v217, v215
    v_accvgpr_write_b32 a173, v217
    v_accvgpr_read_b32 v218, a174
    v_mul_f32 v218, v218, v215
    v_accvgpr_write_b32 a174, v218
    v_accvgpr_read_b32 v219, a175
    v_mul_f32 v219, v219, v215
    v_accvgpr_write_b32 a175, v219
    v_accvgpr_read_b32 v216, a176
    v_mul_f32 v216, v216, v215
    v_accvgpr_write_b32 a176, v216
    v_accvgpr_read_b32 v217, a177
    v_mul_f32 v217, v217, v215
    v_accvgpr_write_b32 a177, v217
    v_accvgpr_read_b32 v218, a178
    v_mul_f32 v218, v218, v215
    v_accvgpr_write_b32 a178, v218
    v_accvgpr_read_b32 v219, a179
    v_mul_f32 v219, v219, v215
    v_accvgpr_write_b32 a179, v219
    v_accvgpr_read_b32 v216, a180
    v_mul_f32 v216, v216, v215
    v_accvgpr_write_b32 a180, v216
    v_accvgpr_read_b32 v217, a181
    v_mul_f32 v217, v217, v215
    v_accvgpr_write_b32 a181, v217
    v_accvgpr_read_b32 v218, a182
    v_mul_f32 v218, v218, v215
    v_accvgpr_write_b32 a182, v218
    v_accvgpr_read_b32 v219, a183
    v_mul_f32 v219, v219, v215
    v_accvgpr_write_b32 a183, v219
    v_accvgpr_read_b32 v216, a184
    v_mul_f32 v216, v216, v215
    v_accvgpr_write_b32 a184, v216
    v_accvgpr_read_b32 v217, a185
    v_mul_f32 v217, v217, v215
    v_accvgpr_write_b32 a185, v217
    v_accvgpr_read_b32 v218, a186
    v_mul_f32 v218, v218, v215
    v_accvgpr_write_b32 a186, v218
    v_accvgpr_read_b32 v219, a187
    v_mul_f32 v219, v219, v215
    v_accvgpr_write_b32 a187, v219
    v_accvgpr_read_b32 v216, a188
    v_mul_f32 v216, v216, v215
    v_accvgpr_write_b32 a188, v216
    v_accvgpr_read_b32 v217, a189
    v_mul_f32 v217, v217, v215
    v_accvgpr_write_b32 a189, v217
    v_accvgpr_read_b32 v218, a190
    v_mul_f32 v218, v218, v215
    v_accvgpr_write_b32 a190, v218
    v_accvgpr_read_b32 v219, a191
    v_mul_f32 v219, v219, v215
    v_accvgpr_write_b32 a191, v219
    s_branch BACK_0_2
RARE_1_0:
    v_mov_b32 v213, v212
    s_nop 1
    v_permlane32_swap_b32 v212, v213
    v_max_f32 v212, v212, v213
    v_add_f32 v212, v212, v203
    v_cvt_pk_bf16_f32 v213, v212, v212
    v_lshlrev_b32 v213, 16, v213
    v_max_f32 v213, v213, v200
    v_sub_f32 v214, v203, v213
    v_sub_f32 v215, v200, v213
    v_exp_f32 v215, v215
    v_mov_b32 v200, v213
    v_mov_b32 v203, v213
    v_cvt_pk_bf16_f32 v184, -v213, 0
    v_mov_b32 v206, 0x41000000
    v_mul_f32 v209, v209, v215
    v_add_f32 v16, v16, v214
    v_add_f32 v17, v17, v214
    v_add_f32 v18, v18, v214
    v_add_f32 v19, v19, v214
    v_add_f32 v20, v20, v214
    v_add_f32 v21, v21, v214
    v_add_f32 v22, v22, v214
    v_add_f32 v23, v23, v214
    v_add_f32 v24, v24, v214
    v_add_f32 v25, v25, v214
    v_add_f32 v26, v26, v214
    v_add_f32 v27, v27, v214
    v_add_f32 v28, v28, v214
    v_add_f32 v29, v29, v214
    v_add_f32 v30, v30, v214
    v_add_f32 v31, v31, v214
    v_accvgpr_read_b32 v216, a0
    v_mul_f32 v216, v216, v215
    v_accvgpr_write_b32 a0, v216
    v_accvgpr_read_b32 v217, a1
    v_mul_f32 v217, v217, v215
    v_accvgpr_write_b32 a1, v217
    v_accvgpr_read_b32 v218, a2
    v_mul_f32 v218, v218, v215
    v_accvgpr_write_b32 a2, v218
    v_accvgpr_read_b32 v219, a3
    v_mul_f32 v219, v219, v215
    v_accvgpr_write_b32 a3, v219
    v_accvgpr_read_b32 v216, a4
    v_mul_f32 v216, v216, v215
    v_accvgpr_write_b32 a4, v216
    v_accvgpr_read_b32 v217, a5
    v_mul_f32 v217, v217, v215
    v_accvgpr_write_b32 a5, v217
    v_accvgpr_read_b32 v218, a6
    v_mul_f32 v218, v218, v215
    v_accvgpr_write_b32 a6, v218
    v_accvgpr_read_b32 v219, a7
    v_mul_f32 v219, v219, v215
    v_accvgpr_write_b32 a7, v219
    v_accvgpr_read_b32 v216, a8
    v_mul_f32 v216, v216, v215
    v_accvgpr_write_b32 a8, v216
    v_accvgpr_read_b32 v217, a9
    v_mul_f32 v217, v217, v215
    v_accvgpr_write_b32 a9, v217
    v_accvgpr_read_b32 v218, a10
    v_mul_f32 v218, v218, v215
    v_accvgpr_write_b32 a10, v218
    v_accvgpr_read_b32 v219, a11
    v_mul_f32 v219, v219, v215
    v_accvgpr_write_b32 a11, v219
    v_accvgpr_read_b32 v216, a12
    v_mul_f32 v216, v216, v215
    v_accvgpr_write_b32 a12, v216
    v_accvgpr_read_b32 v217, a13
    v_mul_f32 v217, v217, v215
    v_accvgpr_write_b32 a13, v217
    v_accvgpr_read_b32 v218, a14
    v_mul_f32 v218, v218, v215
    v_accvgpr_write_b32 a14, v218
    v_accvgpr_read_b32 v219, a15
    v_mul_f32 v219, v219, v215
    v_accvgpr_write_b32 a15, v219
    v_accvgpr_read_b32 v216, a16
    v_mul_f32 v216, v216, v215
    v_accvgpr_write_b32 a16, v216
    v_accvgpr_read_b32 v217, a17
    v_mul_f32 v217, v217, v215
    v_accvgpr_write_b32 a17, v217
    v_accvgpr_read_b32 v218, a18
    v_mul_f32 v218, v218, v215
    v_accvgpr_write_b32 a18, v218
    v_accvgpr_read_b32 v219, a19
    v_mul_f32 v219, v219, v215
    v_accvgpr_write_b32 a19, v219
    v_accvgpr_read_b32 v216, a20
    v_mul_f32 v216, v216, v215
    v_accvgpr_write_b32 a20, v216
    v_accvgpr_read_b32 v217, a21
    v_mul_f32 v217, v217, v215
    v_accvgpr_write_b32 a21, v217
    v_accvgpr_read_b32 v218, a22
    v_mul_f32 v218, v218, v215
    v_accvgpr_write_b32 a22, v218
    v_accvgpr_read_b32 v219, a23
    v_mul_f32 v219, v219, v215
    v_accvgpr_write_b32 a23, v219
    v_accvgpr_read_b32 v216, a24
    v_mul_f32 v216, v216, v215
    v_accvgpr_write_b32 a24, v216
    v_accvgpr_read_b32 v217, a25
    v_mul_f32 v217, v217, v215
    v_accvgpr_write_b32 a25, v217
    v_accvgpr_read_b32 v218, a26
    v_mul_f32 v218, v218, v215
    v_accvgpr_write_b32 a26, v218
    v_accvgpr_read_b32 v219, a27
    v_mul_f32 v219, v219, v215
    v_accvgpr_write_b32 a27, v219
    v_accvgpr_read_b32 v216, a28
    v_mul_f32 v216, v216, v215
    v_accvgpr_write_b32 a28, v216
    v_accvgpr_read_b32 v217, a29
    v_mul_f32 v217, v217, v215
    v_accvgpr_write_b32 a29, v217
    v_accvgpr_read_b32 v218, a30
    v_mul_f32 v218, v218, v215
    v_accvgpr_write_b32 a30, v218
    v_accvgpr_read_b32 v219, a31
    v_mul_f32 v219, v219, v215
    v_accvgpr_write_b32 a31, v219
    v_accvgpr_read_b32 v216, a32
    v_mul_f32 v216, v216, v215
    v_accvgpr_write_b32 a32, v216
    v_accvgpr_read_b32 v217, a33
    v_mul_f32 v217, v217, v215
    v_accvgpr_write_b32 a33, v217
    v_accvgpr_read_b32 v218, a34
    v_mul_f32 v218, v218, v215
    v_accvgpr_write_b32 a34, v218
    v_accvgpr_read_b32 v219, a35
    v_mul_f32 v219, v219, v215
    v_accvgpr_write_b32 a35, v219
    v_accvgpr_read_b32 v216, a36
    v_mul_f32 v216, v216, v215
    v_accvgpr_write_b32 a36, v216
    v_accvgpr_read_b32 v217, a37
    v_mul_f32 v217, v217, v215
    v_accvgpr_write_b32 a37, v217
    v_accvgpr_read_b32 v218, a38
    v_mul_f32 v218, v218, v215
    v_accvgpr_write_b32 a38, v218
    v_accvgpr_read_b32 v219, a39
    v_mul_f32 v219, v219, v215
    v_accvgpr_write_b32 a39, v219
    v_accvgpr_read_b32 v216, a40
    v_mul_f32 v216, v216, v215
    v_accvgpr_write_b32 a40, v216
    v_accvgpr_read_b32 v217, a41
    v_mul_f32 v217, v217, v215
    v_accvgpr_write_b32 a41, v217
    v_accvgpr_read_b32 v218, a42
    v_mul_f32 v218, v218, v215
    v_accvgpr_write_b32 a42, v218
    v_accvgpr_read_b32 v219, a43
    v_mul_f32 v219, v219, v215
    v_accvgpr_write_b32 a43, v219
    v_accvgpr_read_b32 v216, a44
    v_mul_f32 v216, v216, v215
    v_accvgpr_write_b32 a44, v216
    v_accvgpr_read_b32 v217, a45
    v_mul_f32 v217, v217, v215
    v_accvgpr_write_b32 a45, v217
    v_accvgpr_read_b32 v218, a46
    v_mul_f32 v218, v218, v215
    v_accvgpr_write_b32 a46, v218
    v_accvgpr_read_b32 v219, a47
    v_mul_f32 v219, v219, v215
    v_accvgpr_write_b32 a47, v219
    v_accvgpr_read_b32 v216, a48
    v_mul_f32 v216, v216, v215
    v_accvgpr_write_b32 a48, v216
    v_accvgpr_read_b32 v217, a49
    v_mul_f32 v217, v217, v215
    v_accvgpr_write_b32 a49, v217
    v_accvgpr_read_b32 v218, a50
    v_mul_f32 v218, v218, v215
    v_accvgpr_write_b32 a50, v218
    v_accvgpr_read_b32 v219, a51
    v_mul_f32 v219, v219, v215
    v_accvgpr_write_b32 a51, v219
    v_accvgpr_read_b32 v216, a52
    v_mul_f32 v216, v216, v215
    v_accvgpr_write_b32 a52, v216
    v_accvgpr_read_b32 v217, a53
    v_mul_f32 v217, v217, v215
    v_accvgpr_write_b32 a53, v217
    v_accvgpr_read_b32 v218, a54
    v_mul_f32 v218, v218, v215
    v_accvgpr_write_b32 a54, v218
    v_accvgpr_read_b32 v219, a55
    v_mul_f32 v219, v219, v215
    v_accvgpr_write_b32 a55, v219
    v_accvgpr_read_b32 v216, a56
    v_mul_f32 v216, v216, v215
    v_accvgpr_write_b32 a56, v216
    v_accvgpr_read_b32 v217, a57
    v_mul_f32 v217, v217, v215
    v_accvgpr_write_b32 a57, v217
    v_accvgpr_read_b32 v218, a58
    v_mul_f32 v218, v218, v215
    v_accvgpr_write_b32 a58, v218
    v_accvgpr_read_b32 v219, a59
    v_mul_f32 v219, v219, v215
    v_accvgpr_write_b32 a59, v219
    v_accvgpr_read_b32 v216, a60
    v_mul_f32 v216, v216, v215
    v_accvgpr_write_b32 a60, v216
    v_accvgpr_read_b32 v217, a61
    v_mul_f32 v217, v217, v215
    v_accvgpr_write_b32 a61, v217
    v_accvgpr_read_b32 v218, a62
    v_mul_f32 v218, v218, v215
    v_accvgpr_write_b32 a62, v218
    v_accvgpr_read_b32 v219, a63
    v_mul_f32 v219, v219, v215
    v_accvgpr_write_b32 a63, v219
    s_branch BACK_1_0
RARE_1_1:
    v_mov_b32 v213, v212
    s_nop 1
    v_permlane32_swap_b32 v212, v213
    v_max_f32 v212, v212, v213
    v_add_f32 v212, v212, v204
    v_cvt_pk_bf16_f32 v213, v212, v212
    v_lshlrev_b32 v213, 16, v213
    v_max_f32 v213, v213, v201
    v_sub_f32 v214, v204, v213
    v_sub_f32 v215, v201, v213
    v_exp_f32 v215, v215
    v_mov_b32 v201, v213
    v_mov_b32 v204, v213
    v_cvt_pk_bf16_f32 v188, -v213, 0
    v_mov_b32 v207, 0x41000000
    v_mul_f32 v210, v210, v215
    v_add_f32 v32, v32, v214
    v_add_f32 v33, v33, v214
    v_add_f32 v34, v34, v214
    v_add_f32 v35, v35, v214
    v_add_f32 v36, v36, v214
    v_add_f32 v37, v37, v214
    v_add_f32 v38, v38, v214
    v_add_f32 v39, v39, v214
    v_add_f32 v40, v40, v214
    v_add_f32 v41, v41, v214
    v_add_f32 v42, v42, v214
    v_add_f32 v43, v43, v214
    v_add_f32 v44, v44, v214
    v_add_f32 v45, v45, v214
    v_add_f32 v46, v46, v214
    v_add_f32 v47, v47, v214
    v_accvgpr_read_b32 v216, a64
    v_mul_f32 v216, v216, v215
    v_accvgpr_write_b32 a64, v216
    v_accvgpr_read_b32 v217, a65
    v_mul_f32 v217, v217, v215
    v_accvgpr_write_b32 a65, v217
    v_accvgpr_read_b32 v218, a66
    v_mul_f32 v218, v218, v215
    v_accvgpr_write_b32 a66, v218
    v_accvgpr_read_b32 v219, a67
    v_mul_f32 v219, v219, v215
    v_accvgpr_write_b32 a67, v219
    v_accvgpr_read_b32 v216, a68
    v_mul_f32 v216, v216, v215
    v_accvgpr_write_b32 a68, v216
    v_accvgpr_read_b32 v217, a69
    v_mul_f32 v217, v217, v215
    v_accvgpr_write_b32 a69, v217
    v_accvgpr_read_b32 v218, a70
    v_mul_f32 v218, v218, v215
    v_accvgpr_write_b32 a70, v218
    v_accvgpr_read_b32 v219, a71
    v_mul_f32 v219, v219, v215
    v_accvgpr_write_b32 a71, v219
    v_accvgpr_read_b32 v216, a72
    v_mul_f32 v216, v216, v215
    v_accvgpr_write_b32 a72, v216
    v_accvgpr_read_b32 v217, a73
    v_mul_f32 v217, v217, v215
    v_accvgpr_write_b32 a73, v217
    v_accvgpr_read_b32 v218, a74
    v_mul_f32 v218, v218, v215
    v_accvgpr_write_b32 a74, v218
    v_accvgpr_read_b32 v219, a75
    v_mul_f32 v219, v219, v215
    v_accvgpr_write_b32 a75, v219
    v_accvgpr_read_b32 v216, a76
    v_mul_f32 v216, v216, v215
    v_accvgpr_write_b32 a76, v216
    v_accvgpr_read_b32 v217, a77
    v_mul_f32 v217, v217, v215
    v_accvgpr_write_b32 a77, v217
    v_accvgpr_read_b32 v218, a78
    v_mul_f32 v218, v218, v215
    v_accvgpr_write_b32 a78, v218
    v_accvgpr_read_b32 v219, a79
    v_mul_f32 v219, v219, v215
    v_accvgpr_write_b32 a79, v219
    v_accvgpr_read_b32 v216, a80
    v_mul_f32 v216, v216, v215
    v_accvgpr_write_b32 a80, v216
    v_accvgpr_read_b32 v217, a81
    v_mul_f32 v217, v217, v215
    v_accvgpr_write_b32 a81, v217
    v_accvgpr_read_b32 v218, a82
    v_mul_f32 v218, v218, v215
    v_accvgpr_write_b32 a82, v218
    v_accvgpr_read_b32 v219, a83
    v_mul_f32 v219, v219, v215
    v_accvgpr_write_b32 a83, v219
    v_accvgpr_read_b32 v216, a84
    v_mul_f32 v216, v216, v215
    v_accvgpr_write_b32 a84, v216
    v_accvgpr_read_b32 v217, a85
    v_mul_f32 v217, v217, v215
    v_accvgpr_write_b32 a85, v217
    v_accvgpr_read_b32 v218, a86
    v_mul_f32 v218, v218, v215
    v_accvgpr_write_b32 a86, v218
    v_accvgpr_read_b32 v219, a87
    v_mul_f32 v219, v219, v215
    v_accvgpr_write_b32 a87, v219
    v_accvgpr_read_b32 v216, a88
    v_mul_f32 v216, v216, v215
    v_accvgpr_write_b32 a88, v216
    v_accvgpr_read_b32 v217, a89
    v_mul_f32 v217, v217, v215
    v_accvgpr_write_b32 a89, v217
    v_accvgpr_read_b32 v218, a90
    v_mul_f32 v218, v218, v215
    v_accvgpr_write_b32 a90, v218
    v_accvgpr_read_b32 v219, a91
    v_mul_f32 v219, v219, v215
    v_accvgpr_write_b32 a91, v219
    v_accvgpr_read_b32 v216, a92
    v_mul_f32 v216, v216, v215
    v_accvgpr_write_b32 a92, v216
    v_accvgpr_read_b32 v217, a93
    v_mul_f32 v217, v217, v215
    v_accvgpr_write_b32 a93, v217
    v_accvgpr_read_b32 v218, a94
    v_mul_f32 v218, v218, v215
    v_accvgpr_write_b32 a94, v218
    v_accvgpr_read_b32 v219, a95
    v_mul_f32 v219, v219, v215
    v_accvgpr_write_b32 a95, v219
    v_accvgpr_read_b32 v216, a96
    v_mul_f32 v216, v216, v215
    v_accvgpr_write_b32 a96, v216
    v_accvgpr_read_b32 v217, a97
    v_mul_f32 v217, v217, v215
    v_accvgpr_write_b32 a97, v217
    v_accvgpr_read_b32 v218, a98
    v_mul_f32 v218, v218, v215
    v_accvgpr_write_b32 a98, v218
    v_accvgpr_read_b32 v219, a99
    v_mul_f32 v219, v219, v215
    v_accvgpr_write_b32 a99, v219
    v_accvgpr_read_b32 v216, a100
    v_mul_f32 v216, v216, v215
    v_accvgpr_write_b32 a100, v216
    v_accvgpr_read_b32 v217, a101
    v_mul_f32 v217, v217, v215
    v_accvgpr_write_b32 a101, v217
    v_accvgpr_read_b32 v218, a102
    v_mul_f32 v218, v218, v215
    v_accvgpr_write_b32 a102, v218
    v_accvgpr_read_b32 v219, a103
    v_mul_f32 v219, v219, v215
    v_accvgpr_write_b32 a103, v219
    v_accvgpr_read_b32 v216, a104
    v_mul_f32 v216, v216, v215
    v_accvgpr_write_b32 a104, v216
    v_accvgpr_read_b32 v217, a105
    v_mul_f32 v217, v217, v215
    v_accvgpr_write_b32 a105, v217
    v_accvgpr_read_b32 v218, a106
    v_mul_f32 v218, v218, v215
    v_accvgpr_write_b32 a106, v218
    v_accvgpr_read_b32 v219, a107
    v_mul_f32 v219, v219, v215
    v_accvgpr_write_b32 a107, v219
    v_accvgpr_read_b32 v216, a108
    v_mul_f32 v216, v216, v215
    v_accvgpr_write_b32 a108, v216
    v_accvgpr_read_b32 v217, a109
    v_mul_f32 v217, v217, v215
    v_accvgpr_write_b32 a109, v217
    v_accvgpr_read_b32 v218, a110
    v_mul_f32 v218, v218, v215
    v_accvgpr_write_b32 a110, v218
    v_accvgpr_read_b32 v219, a111
    v_mul_f32 v219, v219, v215
    v_accvgpr_write_b32 a111, v219
    v_accvgpr_read_b32 v216, a112
    v_mul_f32 v216, v216, v215
    v_accvgpr_write_b32 a112, v216
    v_accvgpr_read_b32 v217, a113
    v_mul_f32 v217, v217, v215
    v_accvgpr_write_b32 a113, v217
    v_accvgpr_read_b32 v218, a114
    v_mul_f32 v218, v218, v215
    v_accvgpr_write_b32 a114, v218
    v_accvgpr_read_b32 v219, a115
    v_mul_f32 v219, v219, v215
    v_accvgpr_write_b32 a115, v219
    v_accvgpr_read_b32 v216, a116
    v_mul_f32 v216, v216, v215
    v_accvgpr_write_b32 a116, v216
    v_accvgpr_read_b32 v217, a117
    v_mul_f32 v217, v217, v215
    v_accvgpr_write_b32 a117, v217
    v_accvgpr_read_b32 v218, a118
    v_mul_f32 v218, v218, v215
    v_accvgpr_write_b32 a118, v218
    v_accvgpr_read_b32 v219, a119
    v_mul_f32 v219, v219, v215
    v_accvgpr_write_b32 a119, v219
    v_accvgpr_read_b32 v216, a120
    v_mul_f32 v216, v216, v215
    v_accvgpr_write_b32 a120, v216
    v_accvgpr_read_b32 v217, a121
    v_mul_f32 v217, v217, v215
    v_accvgpr_write_b32 a121, v217
    v_accvgpr_read_b32 v218, a122
    v_mul_f32 v218, v218, v215
    v_accvgpr_write_b32 a122, v218
    v_accvgpr_read_b32 v219, a123
    v_mul_f32 v219, v219, v215
    v_accvgpr_write_b32 a123, v219
    v_accvgpr_read_b32 v216, a124
    v_mul_f32 v216, v216, v215
    v_accvgpr_write_b32 a124, v216
    v_accvgpr_read_b32 v217, a125
    v_mul_f32 v217, v217, v215
    v_accvgpr_write_b32 a125, v217
    v_accvgpr_read_b32 v218, a126
    v_mul_f32 v218, v218, v215
    v_accvgpr_write_b32 a126, v218
    v_accvgpr_read_b32 v219, a127
    v_mul_f32 v219, v219, v215
    v_accvgpr_write_b32 a127, v219
    s_branch BACK_1_1
RARE_1_2:
    v_mov_b32 v213, v212
    s_nop 1
    v_permlane32_swap_b32 v212, v213
    v_max_f32 v212, v212, v213
    v_add_f32 v212, v212, v205
    v_cvt_pk_bf16_f32 v213, v212, v212
    v_lshlrev_b32 v213, 16, v213
    v_max_f32 v213, v213, v202
    v_sub_f32 v214, v205, v213
    v_sub_f32 v215, v202, v213
    v_exp_f32 v215, v215
    v_mov_b32 v202, v213
    v_mov_b32 v205, v213
    v_cvt_pk_bf16_f32 v192, -v213, 0
    v_mov_b32 v208, 0x41000000
    v_mul_f32 v211, v211, v215
    v_add_f32 v48, v48, v214
    v_add_f32 v49, v49, v214
    v_add_f32 v50, v50, v214
    v_add_f32 v51, v51, v214
    v_add_f32 v52, v52, v214
    v_add_f32 v53, v53, v214
    v_add_f32 v54, v54, v214
    v_add_f32 v55, v55, v214
    v_add_f32 v56, v56, v214
    v_add_f32 v57, v57, v214
    v_add_f32 v58, v58, v214
    v_add_f32 v59, v59, v214
    v_add_f32 v60, v60, v214
    v_add_f32 v61, v61, v214
    v_add_f32 v62, v62, v214
    v_add_f32 v63, v63, v214
    v_accvgpr_read_b32 v216, a128
    v_mul_f32 v216, v216, v215
    v_accvgpr_write_b32 a128, v216
    v_accvgpr_read_b32 v217, a129
    v_mul_f32 v217, v217, v215
    v_accvgpr_write_b32 a129, v217
    v_accvgpr_read_b32 v218, a130
    v_mul_f32 v218, v218, v215
    v_accvgpr_write_b32 a130, v218
    v_accvgpr_read_b32 v219, a131
    v_mul_f32 v219, v219, v215
    v_accvgpr_write_b32 a131, v219
    v_accvgpr_read_b32 v216, a132
    v_mul_f32 v216, v216, v215
    v_accvgpr_write_b32 a132, v216
    v_accvgpr_read_b32 v217, a133
    v_mul_f32 v217, v217, v215
    v_accvgpr_write_b32 a133, v217
    v_accvgpr_read_b32 v218, a134
    v_mul_f32 v218, v218, v215
    v_accvgpr_write_b32 a134, v218
    v_accvgpr_read_b32 v219, a135
    v_mul_f32 v219, v219, v215
    v_accvgpr_write_b32 a135, v219
    v_accvgpr_read_b32 v216, a136
    v_mul_f32 v216, v216, v215
    v_accvgpr_write_b32 a136, v216
    v_accvgpr_read_b32 v217, a137
    v_mul_f32 v217, v217, v215
    v_accvgpr_write_b32 a137, v217
    v_accvgpr_read_b32 v218, a138
    v_mul_f32 v218, v218, v215
    v_accvgpr_write_b32 a138, v218
    v_accvgpr_read_b32 v219, a139
    v_mul_f32 v219, v219, v215
    v_accvgpr_write_b32 a139, v219
    v_accvgpr_read_b32 v216, a140
    v_mul_f32 v216, v216, v215
    v_accvgpr_write_b32 a140, v216
    v_accvgpr_read_b32 v217, a141
    v_mul_f32 v217, v217, v215
    v_accvgpr_write_b32 a141, v217
    v_accvgpr_read_b32 v218, a142
    v_mul_f32 v218, v218, v215
    v_accvgpr_write_b32 a142, v218
    v_accvgpr_read_b32 v219, a143
    v_mul_f32 v219, v219, v215
    v_accvgpr_write_b32 a143, v219
    v_accvgpr_read_b32 v216, a144
    v_mul_f32 v216, v216, v215
    v_accvgpr_write_b32 a144, v216
    v_accvgpr_read_b32 v217, a145
    v_mul_f32 v217, v217, v215
    v_accvgpr_write_b32 a145, v217
    v_accvgpr_read_b32 v218, a146
    v_mul_f32 v218, v218, v215
    v_accvgpr_write_b32 a146, v218
    v_accvgpr_read_b32 v219, a147
    v_mul_f32 v219, v219, v215
    v_accvgpr_write_b32 a147, v219
    v_accvgpr_read_b32 v216, a148
    v_mul_f32 v216, v216, v215
    v_accvgpr_write_b32 a148, v216
    v_accvgpr_read_b32 v217, a149
    v_mul_f32 v217, v217, v215
    v_accvgpr_write_b32 a149, v217
    v_accvgpr_read_b32 v218, a150
    v_mul_f32 v218, v218, v215
    v_accvgpr_write_b32 a150, v218
    v_accvgpr_read_b32 v219, a151
    v_mul_f32 v219, v219, v215
    v_accvgpr_write_b32 a151, v219
    v_accvgpr_read_b32 v216, a152
    v_mul_f32 v216, v216, v215
    v_accvgpr_write_b32 a152, v216
    v_accvgpr_read_b32 v217, a153
    v_mul_f32 v217, v217, v215
    v_accvgpr_write_b32 a153, v217
    v_accvgpr_read_b32 v218, a154
    v_mul_f32 v218, v218, v215
    v_accvgpr_write_b32 a154, v218
    v_accvgpr_read_b32 v219, a155
    v_mul_f32 v219, v219, v215
    v_accvgpr_write_b32 a155, v219
    v_accvgpr_read_b32 v216, a156
    v_mul_f32 v216, v216, v215
    v_accvgpr_write_b32 a156, v216
    v_accvgpr_read_b32 v217, a157
    v_mul_f32 v217, v217, v215
    v_accvgpr_write_b32 a157, v217
    v_accvgpr_read_b32 v218, a158
    v_mul_f32 v218, v218, v215
    v_accvgpr_write_b32 a158, v218
    v_accvgpr_read_b32 v219, a159
    v_mul_f32 v219, v219, v215
    v_accvgpr_write_b32 a159, v219
    v_accvgpr_read_b32 v216, a160
    v_mul_f32 v216, v216, v215
    v_accvgpr_write_b32 a160, v216
    v_accvgpr_read_b32 v217, a161
    v_mul_f32 v217, v217, v215
    v_accvgpr_write_b32 a161, v217
    v_accvgpr_read_b32 v218, a162
    v_mul_f32 v218, v218, v215
    v_accvgpr_write_b32 a162, v218
    v_accvgpr_read_b32 v219, a163
    v_mul_f32 v219, v219, v215
    v_accvgpr_write_b32 a163, v219
    v_accvgpr_read_b32 v216, a164
    v_mul_f32 v216, v216, v215
    v_accvgpr_write_b32 a164, v216
    v_accvgpr_read_b32 v217, a165
    v_mul_f32 v217, v217, v215
    v_accvgpr_write_b32 a165, v217
    v_accvgpr_read_b32 v218, a166
    v_mul_f32 v218, v218, v215
    v_accvgpr_write_b32 a166, v218
    v_accvgpr_read_b32 v219, a167
    v_mul_f32 v219, v219, v215
    v_accvgpr_write_b32 a167, v219
    v_accvgpr_read_b32 v216, a168
    v_mul_f32 v216, v216, v215
    v_accvgpr_write_b32 a168, v216
    v_accvgpr_read_b32 v217, a169
    v_mul_f32 v217, v217, v215
    v_accvgpr_write_b32 a169, v217
    v_accvgpr_read_b32 v218, a170
    v_mul_f32 v218, v218, v215
    v_accvgpr_write_b32 a170, v218
    v_accvgpr_read_b32 v219, a171
    v_mul_f32 v219, v219, v215
    v_accvgpr_write_b32 a171, v219
    v_accvgpr_read_b32 v216, a172
    v_mul_f32 v216, v216, v215
    v_accvgpr_write_b32 a172, v216
    v_accvgpr_read_b32 v217, a173
    v_mul_f32 v217, v217, v215
    v_accvgpr_write_b32 a173, v217
    v_accvgpr_read_b32 v218, a174
    v_mul_f32 v218, v218, v215
    v_accvgpr_write_b32 a174, v218
    v_accvgpr_read_b32 v219, a175
    v_mul_f32 v219, v219, v215
    v_accvgpr_write_b32 a175, v219
    v_accvgpr_read_b32 v216, a176
    v_mul_f32 v216, v216, v215
    v_accvgpr_write_b32 a176, v216
    v_accvgpr_read_b32 v217, a177
    v_mul_f32 v217, v217, v215
    v_accvgpr_write_b32 a177, v217
    v_accvgpr_read_b32 v218, a178
    v_mul_f32 v218, v218, v215
    v_accvgpr_write_b32 a178, v218
    v_accvgpr_read_b32 v219, a179
    v_mul_f32 v219, v219, v215
    v_accvgpr_write_b32 a179, v219
    v_accvgpr_read_b32 v216, a180
    v_mul_f32 v216, v216, v215
    v_accvgpr_write_b32 a180, v216
    v_accvgpr_read_b32 v217, a181
    v_mul_f32 v217, v217, v215
    v_accvgpr_write_b32 a181, v217
    v_accvgpr_read_b32 v218, a182
    v_mul_f32 v218, v218, v215
    v_accvgpr_write_b32 a182, v218
    v_accvgpr_read_b32 v219, a183
    v_mul_f32 v219, v219, v215
    v_accvgpr_write_b32 a183, v219
    v_accvgpr_read_b32 v216, a184
    v_mul_f32 v216, v216, v215
    v_accvgpr_write_b32 a184, v216
    v_accvgpr_read_b32 v217, a185
    v_mul_f32 v217, v217, v215
    v_accvgpr_write_b32 a185, v217
    v_accvgpr_read_b32 v218, a186
    v_mul_f32 v218, v218, v215
    v_accvgpr_write_b32 a186, v218
    v_accvgpr_read_b32 v219, a187
    v_mul_f32 v219, v219, v215
    v_accvgpr_write_b32 a187, v219
    v_accvgpr_read_b32 v216, a188
    v_mul_f32 v216, v216, v215
    v_accvgpr_write_b32 a188, v216
    v_accvgpr_read_b32 v217, a189
    v_mul_f32 v217, v217, v215
    v_accvgpr_write_b32 a189, v217
    v_accvgpr_read_b32 v218, a190
    v_mul_f32 v218, v218, v215
    v_accvgpr_write_b32 a190, v218
    v_accvgpr_read_b32 v219, a191
    v_mul_f32 v219, v219, v215
    v_accvgpr_write_b32 a191, v219
    s_branch BACK_1_2
.section .rodata,"a"
.p2align 6
.amdhsa_kernel standalone__gqa_softmax__near_ridge_kernel
  .amdhsa_next_free_vgpr 512
  .amdhsa_next_free_sgpr 72
  .amdhsa_accum_offset 256
  .amdhsa_group_segment_fixed_size 0
  .amdhsa_kernarg_size 48
  .amdhsa_user_sgpr_count 2
  .amdhsa_user_sgpr_kernarg_segment_ptr 1
  .amdhsa_system_sgpr_workgroup_id_x 1
.end_amdhsa_kernel
```
